```python
import torch

def _softmax(x, axis=-1):
    return torch.softmax(x, dim=axis)
def _gelu(x):
    return torch.nn.functional.gelu(x, approximate="tanh")
def _silu(x):
    return torch.nn.functional.silu(x)
def _sigmoid(x):
    return torch.sigmoid(x)
def _layernorm(x, axis=-1, eps=1e-5):
    m = x.mean(dim=axis, keepdim=True)
    v = x.var(dim=axis, keepdim=True, unbiased=False)
    return (x - m) / torch.sqrt(v + eps)
def _scatter_add(tgt, idx, src, axis=0):
    return tgt.clone().index_add_(axis, idx, src)
def _segment_sum(src, seg, n):
    out = torch.zeros((n,) + src.shape[1:], dtype=src.dtype)
    return out.index_add_(0, seg, src)
def _pad(x, pw):
    flat = tuple(v for pair in reversed(pw) for v in pair)
    return torch.nn.functional.pad(x, flat)

kernel_name = 'sequential_preLN__gqa_block_cached__swiglu_ffn__decode'

def setup_inputs():

    _w = (lambda a: (lambda t: t.to(torch.bfloat16) if t.is_floating_point() else t)(torch.as_tensor(a)))
    def _A_setup():
        B, Sq, D = 2, 1, 512
        Hq, Hkv, Sk, Dh = 32, 8, 16384, 128
        assert Hq % Hkv == 0, (Hq, Hkv)
        return {
            "x": _w((lambda *s: torch.randn(*s, dtype=torch.bfloat16) * 0.05)(B, Sq, D)),
            "k_cache": _w((lambda *s: torch.randn(*s, dtype=torch.bfloat16) * 3.2)(B, Hkv, Sk, Dh)),
            "v_cache": _w((lambda *s: torch.randn(*s, dtype=torch.bfloat16) * 0.4)(B, Hkv, Sk, Dh)),
            "wq": _w((lambda *s: torch.randn(*s, dtype=torch.bfloat16) * 3.2)(D, Hq * Dh) * (D ** -0.5)),
            "wo": _w((lambda *s: torch.randn(*s, dtype=torch.bfloat16) * 0.4)(Hq * Dh, D) * ((Hq * Dh) ** -0.5)),
        }
    _A_in = _A_setup()

    def _B_setup():
        B, S, D, F = 2, 1, 512, 1792
        return {
            "x": _w((lambda *s: torch.randn(*s, dtype=torch.bfloat16) * 0.05)(B, S, D)),
            "w_gate": _w((lambda *s: torch.randn(*s, dtype=torch.bfloat16) * 0.05)(D, F)),
            "w_up": _w((lambda *s: torch.randn(*s, dtype=torch.bfloat16) * 0.05)(D, F)),
            "w_down": _w((lambda *s: torch.randn(*s, dtype=torch.bfloat16) * 0.05)(F, D)),
        }
    _B_in = _B_setup()

    return {
        "A_x": _A_in["x"],
        "A_k_cache": _A_in["k_cache"],
        "A_v_cache": _A_in["v_cache"],
        "A_wq": _A_in["wq"],
        "A_wo": _A_in["wo"],
        "B_x": _B_in["x"],
        "B_w_gate": _B_in["w_gate"],
        "B_w_up": _B_in["w_up"],
        "B_w_down": _B_in["w_down"],
    }

def reference(A_x, A_k_cache, A_v_cache, A_wq, A_wo, B_x, B_w_gate, B_w_up, B_w_down):
    def _A_ref(x, k_cache, v_cache, wq, wo):
        B, Sq, D = x.shape
        Hq, Dh = 32, 128
        Hkv = k_cache.shape[1]
        rep = Hq // Hkv
        q = (lambda x, *d: x.permute(*d))((x @ wq).reshape(B, Sq, Hq, Dh), 0, 2, 1, 3)
        k = (lambda x, n, axis: torch.repeat_interleave(x, n, dim=axis))(k_cache, rep, axis=1)
        v = (lambda x, n, axis: torch.repeat_interleave(x, n, dim=axis))(v_cache, rep, axis=1)
        scores = torch.einsum("bhqd,bhkd->bhqk", q, k) * (Dh ** -0.5)
        p = _softmax(scores, axis=-1)
        o = torch.einsum("bhqk,bhkd->bhqd", p, v)
        return (lambda x, *d: x.permute(*d))(o, 0, 2, 1, 3).reshape(B, Sq, Hq * Dh) @ wo

    def _B_ref(x, w_gate, w_up, w_down):
        g = _silu(x @ w_gate)
        u = x @ w_up
        return (g * u) @ w_down

    x = A_x
    h = x + _A_ref(_layernorm(x, axis=-1), A_k_cache, A_v_cache, A_wq, A_wo)
    h2 = h + _B_ref(_layernorm(h, axis=-1), B_w_gate, B_w_up, B_w_down)
    return h2
```

```asm
; @launch grid=(256,1,1) block=(320,1,1) lds=163840
.amdgcn_target "amdgcn-amd-amdhsa--gfx950"
.text
.globl sequential_preLN__gqa_block_cached__swiglu_ffn__decode_kernel
.p2align 8
.type sequential_preLN__gqa_block_cached__swiglu_ffn__decode_kernel,@function
sequential_preLN__gqa_block_cached__swiglu_ffn__decode_kernel:
    s_cmp_ge_u32 s2, 256
    s_cbranch_scc1 L_END
    s_load_dwordx16 s[4:19], s[0:1], 0
    s_load_dwordx8 s[20:27], s[0:1], 64
    v_and_b32 v1, 63, v0
    v_lshrrev_b32 v2, 6, v0
    s_and_b32 s29, s2, 7
    v_readfirstlane_b32 s28, v2
    s_lshr_b32 s30, s2, 3
    s_lshr_b32 s31, s30, 4
    s_and_b32 s32, s30, 15
    s_lshl_b32 s35, s31, 3
    s_add_u32 s35, s35, s29
    s_cmp_lg_u32 s28, 4
    s_cbranch_scc1 L_STREAM
    s_setprio 3
    s_and_b32 s90, s30, 3
    s_lshr_b32 s91, s30, 2
    s_lshl_b32 s86, s29, 10
    s_lshl_b32 s87, s91, 7
    s_add_u32 s86, s86, s87
    s_lshl_b32 s87, s90, 20
    s_add_u32 s86, s86, s87
    v_lshlrev_b32 v3, 4, v1
    v_mov_b32 v4, 151688
    v_mov_b32 v8, 0
    v_mov_b32 v9, 0
    ds_write_b64 v4, v[8:9]
    ds_write_b32 v4, v8 offset:8
    s_waitcnt lgkmcnt(0)
    s_barrier
    global_load_dwordx4 v[8:11], v3, s[4:5]
    global_load_dwordx4 v[12:15], v3, s[4:5] offset:1024
    v_mov_b32 v6, 0
    global_load_dword v22, v6, s[26:27] sc1
    s_branch L_SERVICE_B
L_STREAM:
    s_setprio 2
    v_lshrrev_b32 v4, 4, v1
    v_and_b32 v5, 15, v1
    v_lshlrev_b32 v6, 1, v4
    v_xor_b32 v5, v5, v6
    v_lshlrev_b32 v5, 4, v5
    v_lshl_or_b32 v2, v4, 8, v5
    v_xor_b32 v3, 128, v2
    s_lshl_b32 s48, s35, 4
    s_add_u32 s48, s48, s32
    s_lshl_b32 s48, s48, 18
    s_add_u32 s50, s28, 0
    s_and_b32 s50, s50, 3
    s_lshl_b32 s50, s50, 12
    s_add_u32 s48, s48, s50
    s_mul_i32 s49, s32, 1
    s_mul_i32 s51, s29, 0
    s_add_u32 s49, s49, s51
    s_and_b32 s49, s49, 15
    s_lshl_b32 s49, s49, 14
    s_lshl_b32 s51, s28, 15
    s_and_b32 s90, s30, 3
    s_lshr_b32 s91, s30, 2
    s_lshl_b32 s86, s29, 10
    s_lshl_b32 s87, s91, 7
    s_add_u32 s86, s86, s87
    s_lshl_b32 s87, s90, 20
    s_add_u32 s86, s86, s87
    v_lshrrev_b32 v8, 3, v1
    v_lshlrev_b32 v8, 13, v8
    v_and_b32 v9, 7, v1
    v_lshl_add_u32 v8, v9, 4, v8
    s_lshl_b32 s87, s28, 18
    s_add_u32 s86, s86, s87
    s_lshl_b32 s90, s28, 12
    s_add_u32 s90, s90, 131072
    s_waitcnt lgkmcnt(0)
    s_barrier
    s_mov_b32 s44, s10
    s_mov_b32 s45, s11
    s_mov_b32 s46, 4194304
    s_mov_b32 s47, 0x20000
    s_add_u32 m0, s90, 0
    s_add_u32 s50, s86, 0
    buffer_load_dwordx4 v8, s[44:47], s50 offen nt lds
    s_add_u32 m0, s90, 1024
    s_add_u32 s50, s86, 65536
    buffer_load_dwordx4 v8, s[44:47], s50 offen nt lds
    s_add_u32 m0, s90, 2048
    s_add_u32 s50, s86, 131072
    buffer_load_dwordx4 v8, s[44:47], s50 offen nt lds
    s_add_u32 m0, s90, 3072
    s_add_u32 s50, s86, 196608
    buffer_load_dwordx4 v8, s[44:47], s50 offen nt lds
    s_mov_b32 s36, s6
    s_mov_b32 s37, s7
    s_mov_b32 s38, 67108864
    s_mov_b32 s39, 0x20000
    s_add_u32 m0, s51, 0
    s_add_u32 s50, s48, s49
    buffer_load_dwordx4 v2, s[36:39], s50 offen offset:0 nt lds
    buffer_load_dwordx4 v3, s[36:39], s50 offen offset:1024 nt lds
    buffer_load_dwordx4 v2, s[36:39], s50 offen offset:2048 nt lds
    buffer_load_dwordx4 v3, s[36:39], s50 offen offset:3072 nt lds
    s_add_u32 s49, s49, 0x4000
    s_and_b32 s49, s49, 0x3ffff
    s_mov_b32 s40, s8
    s_mov_b32 s41, s9
    s_mov_b32 s42, 67108864
    s_mov_b32 s43, 0x20000
    v_and_b32 v40, 15, v1
    v_lshrrev_b32 v41, 4, v1
    v_and_b32 v42, 7, v40
    v_lshlrev_b32 v42, 1, v42
    v_lshlrev_b32 v43, 8, v40
    v_add_u32 v43, s51, v43
    v_add_u32 v44, 0, v41
    v_xor_b32 v44, v44, v42
    v_lshl_add_u32 v4, v44, 4, v43
    v_add_u32 v44, 4, v41
    v_xor_b32 v44, v44, v42
    v_lshl_add_u32 v5, v44, 4, v43
    v_add_u32 v44, 8, v41
    v_xor_b32 v44, v44, v42
    v_lshl_add_u32 v6, v44, 4, v43
    v_add_u32 v44, 12, v41
    v_xor_b32 v44, v44, v42
    v_lshl_add_u32 v7, v44, 4, v43
    v_lshrrev_b32 v42, 2, v40
    v_lshl_add_u32 v42, v41, 2, v42
    v_and_b32 v44, 7, v42
    v_lshlrev_b32 v43, 8, v42
    v_and_b32 v45, 3, v1
    v_lshl_add_u32 v43, v45, 3, v43
    v_add_u32 v43, s51, v43
    v_xor_b32 v45, 0, v44
    v_lshl_add_u32 v8, v45, 5, v43
    v_xor_b32 v45, 1, v44
    v_lshl_add_u32 v9, v45, 5, v43
    v_xor_b32 v45, 2, v44
    v_lshl_add_u32 v10, v45, 5, v43
    v_xor_b32 v45, 3, v44
    v_lshl_add_u32 v11, v45, 5, v43
    v_xor_b32 v45, 4, v44
    v_lshl_add_u32 v12, v45, 5, v43
    v_xor_b32 v45, 5, v44
    v_lshl_add_u32 v13, v45, 5, v43
    v_xor_b32 v45, 6, v44
    v_lshl_add_u32 v14, v45, 5, v43
    v_xor_b32 v45, 7, v44
    v_lshl_add_u32 v15, v45, 5, v43
    v_mov_b32 v204, 0x3f803f80
    v_mov_b32 v205, 0x3f803f80
    v_mov_b32 v206, 0x3f803f80
    v_mov_b32 v207, 0x3f803f80
    s_mov_b32 s52, 0x3e0293ee
    s_mov_b32 s54, 0xffffff00
    s_mov_b32 s55, 1048576
    s_add_u32 m0, s51, 4096
    s_add_u32 s50, s48, s49
    buffer_load_dwordx4 v2, s[36:39], s50 offen offset:0 nt lds
    s_waitcnt vmcnt(4)
    v_mov_b32 v48, 151696
    v_mov_b32 v49, 1
    s_mov_b64 exec, 1
    ds_add_u32 v48, v49
    s_mov_b64 exec, -1
    buffer_load_dwordx4 v3, s[36:39], s50 offen offset:1024 nt lds
    s_waitcnt vmcnt(4)
    buffer_load_dwordx4 v2, s[36:39], s50 offen offset:2048 nt lds
    s_waitcnt vmcnt(4)
    buffer_load_dwordx4 v3, s[36:39], s50 offen offset:3072 nt lds
    s_add_u32 s49, s49, 0x4000
    s_and_b32 s49, s49, 0x3ffff
    s_lshl_b32 s34, s29, 4
    s_add_u32 s34, s34, s32
    v_and_b32 v42, 31, v1
    v_lshrrev_b32 v43, 5, v1
    v_lshlrev_b32 v42, 2, v42
    v_lshl_add_u32 v42, v43, 10, v42
    s_and_b32 s86, s30, 7
    s_lshl_b32 s86, s86, 7
    v_add_u32 v42, s86, v42
    global_load_dword v212, v42, s[4:5]
    s_lshl_b32 s86, s31, 10
    s_lshl_b32 s87, s34, 3
    s_add_u32 s86, s86, s87
    v_lshl_add_u32 v43, v41, 1, s86
    global_load_ushort v213, v43, s[4:5]
    s_add_u32 m0, s51, 8192
    s_add_u32 s50, s48, s49
    s_waitcnt vmcnt(4)
    buffer_load_dwordx4 v2, s[36:39], s50 offen offset:0 nt lds
    s_waitcnt vmcnt(4)
    buffer_load_dwordx4 v3, s[36:39], s50 offen offset:1024 nt lds
    s_waitcnt vmcnt(4)
    buffer_load_dwordx4 v2, s[36:39], s50 offen offset:2048 nt lds
    s_waitcnt vmcnt(4)
    buffer_load_dwordx4 v3, s[36:39], s50 offen offset:3072 nt lds
    s_add_u32 s49, s49, 0x4000
    s_and_b32 s49, s49, 0x3ffff
    s_add_u32 m0, s51, 12288
    s_add_u32 s50, s48, s49
    s_waitcnt vmcnt(4)
    buffer_load_dwordx4 v2, s[36:39], s50 offen offset:0 nt lds
    s_waitcnt vmcnt(4)
    buffer_load_dwordx4 v3, s[36:39], s50 offen offset:1024 nt lds
    s_waitcnt vmcnt(4)
    buffer_load_dwordx4 v2, s[36:39], s50 offen offset:2048 nt lds
    s_waitcnt vmcnt(4)
    buffer_load_dwordx4 v3, s[36:39], s50 offen offset:3072 nt lds
    s_add_u32 s49, s49, 0x4000
    s_and_b32 s49, s49, 0x3ffff
    s_add_u32 m0, s51, 16384
    s_add_u32 s50, s48, s49
    s_waitcnt vmcnt(4)
    buffer_load_dwordx4 v2, s[36:39], s50 offen offset:0 nt lds
    s_waitcnt vmcnt(4)
    buffer_load_dwordx4 v3, s[36:39], s50 offen offset:1024 nt lds
    s_waitcnt vmcnt(4)
    buffer_load_dwordx4 v2, s[36:39], s50 offen offset:2048 nt lds
    s_waitcnt vmcnt(4)
    buffer_load_dwordx4 v3, s[36:39], s50 offen offset:3072 nt lds
    s_add_u32 s49, s49, 0x4000
    s_and_b32 s49, s49, 0x3ffff
    s_add_u32 m0, s51, 20480
    s_add_u32 s50, s48, s49
    s_waitcnt vmcnt(4)
    buffer_load_dwordx4 v2, s[36:39], s50 offen offset:0 nt lds
    s_waitcnt vmcnt(4)
    buffer_load_dwordx4 v3, s[36:39], s50 offen offset:1024 nt lds
    s_waitcnt vmcnt(4)
    buffer_load_dwordx4 v2, s[36:39], s50 offen offset:2048 nt lds
    s_waitcnt vmcnt(4)
    buffer_load_dwordx4 v3, s[36:39], s50 offen offset:3072 nt lds
    s_add_u32 s49, s49, 0x4000
    s_and_b32 s49, s49, 0x3ffff
    s_add_u32 m0, s51, 24576
    s_add_u32 s50, s48, s49
    s_waitcnt vmcnt(4)
    buffer_load_dwordx4 v2, s[36:39], s50 offen offset:0 nt lds
    s_waitcnt vmcnt(4)
    buffer_load_dwordx4 v3, s[36:39], s50 offen offset:1024 nt lds
    s_waitcnt vmcnt(4)
    buffer_load_dwordx4 v2, s[36:39], s50 offen offset:2048 nt lds
    s_waitcnt vmcnt(4)
    buffer_load_dwordx4 v3, s[36:39], s50 offen offset:3072 nt lds
    s_add_u32 s49, s49, 0x4000
    s_and_b32 s49, s49, 0x3ffff
    s_add_u32 m0, s51, 28672
    s_add_u32 s50, s48, s49
    s_waitcnt vmcnt(4)
    buffer_load_dwordx4 v2, s[36:39], s50 offen offset:0 nt lds
    s_waitcnt vmcnt(4)
    buffer_load_dwordx4 v3, s[36:39], s50 offen offset:1024 nt lds
    s_waitcnt vmcnt(4)
    buffer_load_dwordx4 v2, s[36:39], s50 offen offset:2048 nt lds
    s_waitcnt vmcnt(4)
    buffer_load_dwordx4 v3, s[36:39], s50 offen offset:3072 nt lds
    s_add_u32 s49, s49, 0x4000
    s_and_b32 s49, s49, 0x3ffff
    v_mov_b32 v41, 151692
Lqf_1:
    ds_read_b32 v42, v41
    s_waitcnt lgkmcnt(0)
    v_cmp_eq_u32 vcc, 0, v42
    s_cbranch_vccz Lqo_2
    s_sub_u32 s55, s55, 1
    s_cbranch_scc0 Lqf_1
    s_branch L_END
Lqo_2:
    v_and_b32 v40, 3, v1
    v_lshlrev_b32 v40, 8, v40
    v_lshrrev_b32 v41, 4, v1
    v_lshl_add_u32 v40, v41, 4, v40
    v_add_u32 v40, 150528, v40
    ds_read_b128 v[16:19], v40 offset:0
    ds_read_b128 v[20:23], v40 offset:64
    ds_read_b128 v[24:27], v40 offset:128
    ds_read_b128 v[28:31], v40 offset:192
    v_mov_b32 v41, 151680
    ds_read_b64 v[42:43], v41
    s_waitcnt lgkmcnt(0)
    v_mov_b32 v214, v42
    v_readfirstlane_b32 s53, v42
    v_readfirstlane_b32 s24, v43
    ds_read_b128 v[32:35], v4 offset:0
    ds_read_b128 v[36:39], v5 offset:0
    ds_read_b128 v[40:43], v6 offset:0
    ds_read_b128 v[44:47], v7 offset:0
    s_waitcnt lgkmcnt(0)
    v_mfma_f32_16x16x32_bf16 v[80:83], v[32:35], v[16:19], 0
    v_mfma_f32_16x16x32_bf16 v[80:83], v[36:39], v[20:23], v[80:83]
    v_mfma_f32_16x16x32_bf16 v[80:83], v[40:43], v[24:27], v[80:83]
    v_mfma_f32_16x16x32_bf16 v[80:83], v[44:47], v[28:31], v[80:83]
    ds_read_b128 v[32:35], v4 offset:4096
    ds_read_b128 v[36:39], v5 offset:4096
    ds_read_b128 v[40:43], v6 offset:4096
    ds_read_b128 v[44:47], v7 offset:4096
    s_add_u32 m0, s51, 0
    s_add_u32 s50, s48, s49
    buffer_load_dwordx4 v2, s[36:39], s50 offen offset:0 nt lds
    s_waitcnt lgkmcnt(0)
    v_mfma_f32_16x16x32_bf16 v[84:87], v[32:35], v[16:19], 0
    v_mfma_f32_16x16x32_bf16 v[84:87], v[36:39], v[20:23], v[84:87]
    buffer_load_dwordx4 v3, s[36:39], s50 offen offset:1024 nt lds
    v_mfma_f32_16x16x32_bf16 v[84:87], v[40:43], v[24:27], v[84:87]
    v_mfma_f32_16x16x32_bf16 v[84:87], v[44:47], v[28:31], v[84:87]
    s_waitcnt vmcnt(6)
    buffer_load_dwordx4 v2, s[36:39], s50 offen offset:2048 nt lds
    s_waitcnt vmcnt(6)
    buffer_load_dwordx4 v3, s[36:39], s50 offen offset:3072 nt lds
    s_add_u32 s49, s49, 0x4000
    s_and_b32 s49, s49, 0x3ffff
    ds_read_b128 v[32:35], v4 offset:8192
    ds_read_b128 v[36:39], v5 offset:8192
    ds_read_b128 v[40:43], v6 offset:8192
    ds_read_b128 v[44:47], v7 offset:8192
    v_max3_f32 v196, v80, v81, v80
    v_max3_f32 v196, v82, v83, v196
    s_waitcnt lgkmcnt(0)
    v_mfma_f32_16x16x32_bf16 v[88:91], v[32:35], v[16:19], 0
    v_mfma_f32_16x16x32_bf16 v[88:91], v[36:39], v[20:23], v[88:91]
    v_mfma_f32_16x16x32_bf16 v[88:91], v[40:43], v[24:27], v[88:91]
    v_mfma_f32_16x16x32_bf16 v[88:91], v[44:47], v[28:31], v[88:91]
    ds_read_b128 v[32:35], v4 offset:12288
    ds_read_b128 v[36:39], v5 offset:12288
    ds_read_b128 v[40:43], v6 offset:12288
    ds_read_b128 v[44:47], v7 offset:12288
    v_max3_f32 v196, v84, v85, v196
    v_max3_f32 v196, v86, v87, v196
    s_add_u32 m0, s51, 4096
    s_add_u32 s50, s48, s49
    s_waitcnt vmcnt(6)
    buffer_load_dwordx4 v2, s[36:39], s50 offen offset:0 nt lds
    s_waitcnt lgkmcnt(0)
    v_mfma_f32_16x16x32_bf16 v[92:95], v[32:35], v[16:19], 0
    v_mfma_f32_16x16x32_bf16 v[92:95], v[36:39], v[20:23], v[92:95]
    s_waitcnt vmcnt(6)
    buffer_load_dwordx4 v3, s[36:39], s50 offen offset:1024 nt lds
    v_mfma_f32_16x16x32_bf16 v[92:95], v[40:43], v[24:27], v[92:95]
    v_mfma_f32_16x16x32_bf16 v[92:95], v[44:47], v[28:31], v[92:95]
    s_waitcnt vmcnt(6)
    buffer_load_dwordx4 v2, s[36:39], s50 offen offset:2048 nt lds
    s_waitcnt vmcnt(6)
    buffer_load_dwordx4 v3, s[36:39], s50 offen offset:3072 nt lds
    s_add_u32 s49, s49, 0x4000
    s_and_b32 s49, s49, 0x3ffff
    ds_read_b128 v[32:35], v4 offset:16384
    ds_read_b128 v[36:39], v5 offset:16384
    ds_read_b128 v[40:43], v6 offset:16384
    ds_read_b128 v[44:47], v7 offset:16384
    v_max3_f32 v196, v88, v89, v196
    v_max3_f32 v196, v90, v91, v196
    s_waitcnt lgkmcnt(0)
    v_mfma_f32_16x16x32_bf16 v[96:99], v[32:35], v[16:19], 0
    v_mfma_f32_16x16x32_bf16 v[96:99], v[36:39], v[20:23], v[96:99]
    v_mfma_f32_16x16x32_bf16 v[96:99], v[40:43], v[24:27], v[96:99]
    v_mfma_f32_16x16x32_bf16 v[96:99], v[44:47], v[28:31], v[96:99]
    ds_read_b128 v[32:35], v4 offset:20480
    ds_read_b128 v[36:39], v5 offset:20480
    ds_read_b128 v[40:43], v6 offset:20480
    ds_read_b128 v[44:47], v7 offset:20480
    v_max3_f32 v196, v92, v93, v196
    v_max3_f32 v196, v94, v95, v196
    s_add_u32 m0, s51, 8192
    s_add_u32 s50, s48, s49
    s_waitcnt vmcnt(6)
    buffer_load_dwordx4 v2, s[36:39], s50 offen offset:0 nt lds
    s_waitcnt lgkmcnt(0)
    v_mfma_f32_16x16x32_bf16 v[100:103], v[32:35], v[16:19], 0
    v_mfma_f32_16x16x32_bf16 v[100:103], v[36:39], v[20:23], v[100:103]
    s_waitcnt vmcnt(6)
    buffer_load_dwordx4 v3, s[36:39], s50 offen offset:1024 nt lds
    v_mfma_f32_16x16x32_bf16 v[100:103], v[40:43], v[24:27], v[100:103]
    v_mfma_f32_16x16x32_bf16 v[100:103], v[44:47], v[28:31], v[100:103]
    s_waitcnt vmcnt(6)
    buffer_load_dwordx4 v2, s[36:39], s50 offen offset:2048 nt lds
    s_waitcnt vmcnt(6)
    buffer_load_dwordx4 v3, s[36:39], s50 offen offset:3072 nt lds
    s_add_u32 s49, s49, 0x4000
    s_and_b32 s49, s49, 0x3ffff
    ds_read_b128 v[32:35], v4 offset:24576
    ds_read_b128 v[36:39], v5 offset:24576
    ds_read_b128 v[40:43], v6 offset:24576
    ds_read_b128 v[44:47], v7 offset:24576
    v_max3_f32 v196, v96, v97, v196
    v_max3_f32 v196, v98, v99, v196
    s_waitcnt lgkmcnt(0)
    v_mfma_f32_16x16x32_bf16 v[104:107], v[32:35], v[16:19], 0
    v_mfma_f32_16x16x32_bf16 v[104:107], v[36:39], v[20:23], v[104:107]
    v_mfma_f32_16x16x32_bf16 v[104:107], v[40:43], v[24:27], v[104:107]
    v_mfma_f32_16x16x32_bf16 v[104:107], v[44:47], v[28:31], v[104:107]
    ds_read_b128 v[32:35], v4 offset:28672
    ds_read_b128 v[36:39], v5 offset:28672
    ds_read_b128 v[40:43], v6 offset:28672
    ds_read_b128 v[44:47], v7 offset:28672
    v_max3_f32 v196, v100, v101, v196
    v_max3_f32 v196, v102, v103, v196
    s_add_u32 m0, s51, 12288
    s_add_u32 s50, s48, s49
    s_waitcnt vmcnt(6)
    buffer_load_dwordx4 v2, s[36:39], s50 offen offset:0 nt lds
    s_waitcnt lgkmcnt(0)
    v_mfma_f32_16x16x32_bf16 v[108:111], v[32:35], v[16:19], 0
    v_mfma_f32_16x16x32_bf16 v[108:111], v[36:39], v[20:23], v[108:111]
    s_waitcnt vmcnt(6)
    buffer_load_dwordx4 v3, s[36:39], s50 offen offset:1024 nt lds
    v_mfma_f32_16x16x32_bf16 v[108:111], v[40:43], v[24:27], v[108:111]
    v_mfma_f32_16x16x32_bf16 v[108:111], v[44:47], v[28:31], v[108:111]
    s_waitcnt vmcnt(6)
    buffer_load_dwordx4 v2, s[36:39], s50 offen offset:2048 nt lds
    s_waitcnt vmcnt(6)
    buffer_load_dwordx4 v3, s[36:39], s50 offen offset:3072 nt lds
    s_add_u32 s49, s49, 0x4000
    s_and_b32 s49, s49, 0x3ffff
    ds_read_b128 v[32:35], v4 offset:0
    ds_read_b128 v[36:39], v5 offset:0
    ds_read_b128 v[40:43], v6 offset:0
    ds_read_b128 v[44:47], v7 offset:0
    v_max3_f32 v196, v104, v105, v196
    v_max3_f32 v196, v106, v107, v196
    s_add_u32 m0, s51, 16384
    s_add_u32 s50, s48, s49
    s_waitcnt vmcnt(6)
    buffer_load_dwordx4 v2, s[36:39], s50 offen offset:0 nt lds
    s_waitcnt lgkmcnt(0)
    v_mfma_f32_16x16x32_bf16 v[112:115], v[32:35], v[16:19], 0
    v_mfma_f32_16x16x32_bf16 v[112:115], v[36:39], v[20:23], v[112:115]
    s_waitcnt vmcnt(6)
    buffer_load_dwordx4 v3, s[36:39], s50 offen offset:1024 nt lds
    v_mfma_f32_16x16x32_bf16 v[112:115], v[40:43], v[24:27], v[112:115]
    v_mfma_f32_16x16x32_bf16 v[112:115], v[44:47], v[28:31], v[112:115]
    s_waitcnt vmcnt(6)
    buffer_load_dwordx4 v2, s[36:39], s50 offen offset:2048 nt lds
    s_waitcnt vmcnt(6)
    buffer_load_dwordx4 v3, s[36:39], s50 offen offset:3072 nt lds
    s_add_u32 s49, s49, 0x4000
    s_and_b32 s49, s49, 0x3ffff
    ds_read_b128 v[32:35], v4 offset:4096
    ds_read_b128 v[36:39], v5 offset:4096
    ds_read_b128 v[40:43], v6 offset:4096
    ds_read_b128 v[44:47], v7 offset:4096
    v_max3_f32 v196, v108, v109, v196
    v_max3_f32 v196, v110, v111, v196
    s_add_u32 m0, s51, 20480
    s_add_u32 s50, s48, s49
    s_waitcnt vmcnt(6)
    buffer_load_dwordx4 v2, s[36:39], s50 offen offset:0 nt lds
    s_waitcnt lgkmcnt(0)
    v_mfma_f32_16x16x32_bf16 v[116:119], v[32:35], v[16:19], 0
    v_mfma_f32_16x16x32_bf16 v[116:119], v[36:39], v[20:23], v[116:119]
    s_waitcnt vmcnt(6)
    buffer_load_dwordx4 v3, s[36:39], s50 offen offset:1024 nt lds
    v_mfma_f32_16x16x32_bf16 v[116:119], v[40:43], v[24:27], v[116:119]
    v_mfma_f32_16x16x32_bf16 v[116:119], v[44:47], v[28:31], v[116:119]
    s_waitcnt vmcnt(6)
    buffer_load_dwordx4 v2, s[36:39], s50 offen offset:2048 nt lds
    s_mov_b64 s[56:57], -1
    s_mov_b32 s58, 0xf000f
    s_mov_b32 s59, 0xf000f
    s_mov_b32 s60, 0x10001
    s_mov_b32 s61, 0x10001
    s_mov_b32 s62, 0xff00ff
    s_mov_b32 s63, 0xff00ff
    s_mov_b32 s76, 0xffffffff
    s_mov_b32 s77, 0x0
    s_mov_b32 s78, 0x1
    s_mov_b32 s79, 0x0
    s_mov_b32 s80, 0x1
    s_mov_b32 s81, 0x1
    s_mov_b32 s82, 0xffffffff
    s_mov_b32 s83, 0xffff
    s_mov_b32 s84, 0xffff0000
    s_mov_b32 s85, 0xffff0000
    s_mov_b32 s14, 0
    s_mov_b32 s15, -1
    s_lshr_b32 s95, s30, 3
    s_and_b32 s93, s30, 7
    s_mov_b32 s94, s95
    s_cmp_lt_u32 s29, 4
    s_cselect_b32 s86, 4, 3
    s_cmp_lt_u32 s95, s86
    s_cselect_b32 s25, -1, 0
    s_sub_u32 s86, s86, 1
    s_min_u32 s95, s95, s86
    s_and_b32 s6, s76, s25
    s_and_b32 s7, s77, s25
    s_and_b32 s8, s80, s25
    s_and_b32 s9, s81, s25
    s_and_b32 s10, s62, s25
    s_and_b32 s11, s63, s25
    s_lshl_b32 s92, s29, 2
    s_mul_i32 s86, s29, 3
    s_add_u32 s86, s86, 4
    s_cmp_lt_u32 s29, 4
    s_cselect_b32 s92, s92, s86
    s_add_u32 s92, s92, s95
    s_min_u32 s92, s92, 27
    s_lshl_b32 s33, s92, 2
    s_and_b32 s86, s30, 3
    s_add_u32 s33, s33, s86
    s_mov_b32 s44, s12
    s_mov_b32 s45, s13
    s_mov_b32 s46, 4194304
    s_mov_b32 s47, 0x20000
    s_mov_b32 s64, s16
    s_mov_b32 s65, s17
    s_mov_b32 s66, 1835008
    s_mov_b32 s67, 0x20000
    s_mov_b32 s68, s18
    s_mov_b32 s69, s19
    s_mov_b32 s70, 1835008
    s_mov_b32 s71, 0x20000
    s_mov_b32 s72, s20
    s_mov_b32 s73, s21
    s_mov_b32 s74, 1835008
    s_mov_b32 s75, 0x20000
    v_and_b32 v48, 15, v1
    v_lshrrev_b32 v49, 4, v1
    v_lshrrev_b32 v52, 2, v48
    v_and_b32 v53, 3, v1
    v_lshlrev_b32 v53, 3, v53
    v_lshrrev_b32 v50, 3, v1
    v_and_b32 v51, 7, v1
    v_lshlrev_b32 v51, 4, v51
    v_lshl_add_u32 v216, v50, 10, v51
    v_mul_u32_u24 v50, 3584, v50
    v_add_u32 v217, v50, v51
    v_lshlrev_b32 v50, 10, v49
    v_lshl_add_u32 v218, v48, 4, v50
    s_mul_i32 s86, s28, 2112
    s_add_u32 s86, s86, 131072
    v_and_b32 v50, 3, v1
    v_mul_u32_u24 v50, 528, v50
    v_lshl_add_u32 v50, v52, 6, v50
    v_lshl_add_u32 v50, v49, 4, v50
    v_add_u32 v219, s86, v50
    s_lshl_b32 s86, s28, 2
    s_add_u32 s86, s86, 151616
    v_and_b32 v50, 3, v1
    v_lshlrev_b32 v50, 4, v50
    v_add_u32 v220, s86, v50
    s_mul_i32 s86, s28, 528
    s_add_u32 s86, s86, 131072
    v_lshlrev_b32 v50, 3, v1
    v_add_u32 v221, s86, v50
    s_lshl_b32 s86, s28, 4
    s_add_u32 s86, s86, 151552
    v_mov_b32 v222, s86
    v_subrev_u32 v254, -64, v222
    s_lshl_b32 s86, s28, 9
    v_lshlrev_b32 v50, 3, v1
    v_add_u32 v223, s86, v50
    s_lshl_b32 s86, s28, 4
    s_add_u32 s86, s86, 2048
    v_mov_b32 v224, s86
    v_lshlrev_b32 v50, 12, v49
    v_lshl_add_u32 v225, v48, 4, v50
    v_add_u32 v226, 16384, v225
    v_add_u32 v227, 32768, v225
    v_add_u32 v228, 49152, v225
    v_and_b32 v50, 3, v1
    v_lshl_add_u32 v50, v50, 2, v49
    v_lshlrev_b32 v50, 12, v50
    s_mul_i32 s86, s94, 496
    s_and_b32 s87, s28, 1
    s_lshl_b32 s87, s87, 8
    s_add_u32 s86, s86, s87
    s_sub_u32 s86, 2048, s86
    v_add_u32 v229, s86, v50
    s_lshl_b32 s86, s28, 7
    s_add_u32 s86, s86, 151744
    v_lshlrev_b32 v50, 3, v48
    v_lshl_add_u32 v50, v49, 1, v50
    v_add_u32 v230, s86, v50
    v_and_b32 v50, 1, v1
    v_lshlrev_b32 v50, 8, v50
    v_lshl_add_u32 v50, v49, 4, v50
    v_add_u32 v231, 151744, v50
    s_lshl_b32 s86, s28, 5
    v_lshl_add_u32 v50, v49, 3, v52
    v_lshl_add_u32 v50, v50, 7, v53
    v_add_u32 v50, s86, v50
    v_add_u32 v232, 24576, v50
    v_add_u32 v233, 90112, v50
    v_and_b32 v50, 1, v49
    v_lshl_add_u32 v50, v50, 3, v52
    v_lshl_add_u32 v50, v50, 7, v53
    v_lshrrev_b32 v51, 1, v49
    v_lshl_add_u32 v50, v51, 15, v50
    v_add_u32 v50, s86, v50
    v_add_u32 v243, 28672, v50
    v_add_u32 v244, 94208, v50
    v_lshl_add_u32 v50, v49, 2, v52
    v_lshlrev_b32 v50, 8, v50
    v_lshl_add_u32 v50, v53, 3, v50
    v_add_u32 v50, s51, v50
    v_add_u32 v245, 0, v50
    s_lshl_b32 s86, s29, 2
    s_add_u32 s86, s86, s94
    s_lshl_b32 s86, s86, 11
    s_lshl_b32 s87, s93, 8
    s_add_u32 s86, s86, s87
    s_lshl_b32 s87, s28, 6
    s_add_u32 s86, s86, s87
    v_and_b32 v50, 1, v49
    v_lshlrev_b32 v50, 16, v50
    v_lshl_add_u32 v50, v48, 2, v50
    v_add_u32 v234, s86, v50
    s_lshl_b32 s86, s28, 14
    s_lshl_b32 s87, s93, 8
    s_add_u32 s86, s86, s87
    v_lshlrev_b32 v50, 11, v49
    v_lshl_add_u32 v50, v48, 4, v50
    v_add_u32 v235, s86, v50
    v_add_u32 v236, 8192, v235
    v_add_u32 v237, 0x10000, v235
    v_add_u32 v238, 0x12000, v235
    s_lshl_b32 s86, s28, 9
    s_add_u32 s86, s86, 152256
    v_lshlrev_b32 v50, 4, v48
    v_lshl_add_u32 v50, v49, 2, v50
    v_add_u32 v239, s86, v50
    v_lshrrev_b32 v50, 5, v1
    v_and_b32 v51, 31, v1
    v_lshlrev_b32 v54, 8, v50
    v_lshl_add_u32 v54, v51, 3, v54
    v_add_u32 v240, 152256, v54
    s_lshl_b32 s86, s28, 8
    s_add_u32 s86, s86, 154304
    v_lshlrev_b32 v54, 7, v50
    v_lshl_add_u32 v54, v51, 2, v54
    v_add_u32 v241, s86, v54
    v_and_b32 v50, 1, v1
    v_lshlrev_b32 v50, 7, v50
    v_lshl_add_u32 v50, v49, 4, v50
    v_add_u32 v50, s86, v50
    v_and_b32 v51, 2, v1
    v_cmp_ne_u32 vcc, 0, v51
    v_mov_b32 v54, 149504
    s_nop 0
    v_cndmask_b32 v242, v50, v54, vcc
    s_lshl_b32 s86, s28, 12
    s_lshl_b32 s87, s93, 9
    s_add_u32 s86, s86, s87
    v_and_b32 v50, 1, v49
    v_lshlrev_b32 v50, 14, v50
    v_lshl_add_u32 v50, v48, 4, v50
    v_add_u32 v246, s86, v50
    s_add_u32 s86, s86, 256
    v_lshrrev_b32 v50, 5, v1
    v_lshlrev_b32 v50, 14, v50
    v_add_u32 v247, s86, v50
    v_lshlrev_b32 v50, 9, v49
    v_lshl_add_u32 v248, v48, 4, v50
    v_and_b32 v50, 7, v1
    v_lshlrev_b32 v50, 9, v50
    v_add_u32 v249, 256, v50
    s_lshl_b32 s86, s28, 9
    v_lshlrev_b32 v50, 7, v49
    v_lshl_add_u32 v50, v48, 4, v50
    v_add_u32 v250, s86, v50
    v_and_b32 v50, 31, v1
    v_lshlrev_b32 v251, 11, v50
    v_lshlrev_b32 v252, 11, v1
    v_add_u32 v255, 0x20000, v252
    v_lshlrev_b32 v253, 1, v49
    s_waitcnt vmcnt(6)
    buffer_load_dwordx4 v3, s[36:39], s50 offen offset:3072 nt lds
    s_add_u32 s49, s49, 0x4000
    s_and_b32 s49, s49, 0x3ffff
    ds_read_b128 v[32:35], v4 offset:8192
    ds_read_b128 v[36:39], v5 offset:8192
    ds_read_b128 v[40:43], v6 offset:8192
    ds_read_b128 v[44:47], v7 offset:8192
    v_max3_f32 v196, v112, v113, v196
    v_max3_f32 v196, v114, v115, v196
    s_add_u32 m0, s51, 24576
    s_add_u32 s50, s48, s49
    s_waitcnt vmcnt(6)
    buffer_load_dwordx4 v2, s[36:39], s50 offen offset:0 nt lds
    s_waitcnt lgkmcnt(0)
    v_mfma_f32_16x16x32_bf16 v[120:123], v[32:35], v[16:19], 0
    v_mfma_f32_16x16x32_bf16 v[120:123], v[36:39], v[20:23], v[120:123]
    s_waitcnt vmcnt(6)
    buffer_load_dwordx4 v3, s[36:39], s50 offen offset:1024 nt lds
    v_mfma_f32_16x16x32_bf16 v[120:123], v[40:43], v[24:27], v[120:123]
    v_mfma_f32_16x16x32_bf16 v[120:123], v[44:47], v[28:31], v[120:123]
    s_waitcnt vmcnt(6)
    buffer_load_dwordx4 v2, s[36:39], s50 offen offset:2048 nt lds
    s_waitcnt vmcnt(6)
    buffer_load_dwordx4 v3, s[36:39], s50 offen offset:3072 nt lds
    s_add_u32 s49, s49, 0x4000
    s_and_b32 s49, s49, 0x3ffff
    ds_read_b128 v[32:35], v4 offset:12288
    ds_read_b128 v[36:39], v5 offset:12288
    ds_read_b128 v[40:43], v6 offset:12288
    ds_read_b128 v[44:47], v7 offset:12288
    v_max3_f32 v196, v116, v117, v196
    v_max3_f32 v196, v118, v119, v196
    s_add_u32 m0, s51, 28672
    s_add_u32 s50, s48, s49
    s_waitcnt vmcnt(6)
    buffer_load_dwordx4 v2, s[36:39], s50 offen offset:0 nt lds
    s_waitcnt lgkmcnt(0)
    v_mfma_f32_16x16x32_bf16 v[124:127], v[32:35], v[16:19], 0
    v_mfma_f32_16x16x32_bf16 v[124:127], v[36:39], v[20:23], v[124:127]
    s_waitcnt vmcnt(6)
    buffer_load_dwordx4 v3, s[36:39], s50 offen offset:1024 nt lds
    v_mfma_f32_16x16x32_bf16 v[124:127], v[40:43], v[24:27], v[124:127]
    v_mfma_f32_16x16x32_bf16 v[124:127], v[44:47], v[28:31], v[124:127]
    s_waitcnt vmcnt(6)
    buffer_load_dwordx4 v2, s[36:39], s50 offen offset:2048 nt lds
    s_waitcnt vmcnt(6)
    buffer_load_dwordx4 v3, s[36:39], s50 offen offset:3072 nt lds
    s_add_u32 s49, s49, 0x4000
    s_and_b32 s49, s49, 0x3ffff
    ds_read_b128 v[32:35], v4 offset:16384
    ds_read_b128 v[36:39], v5 offset:16384
    ds_read_b128 v[40:43], v6 offset:16384
    ds_read_b128 v[44:47], v7 offset:16384
    v_max3_f32 v196, v120, v121, v196
    v_max3_f32 v196, v122, v123, v196
    s_add_u32 m0, s51, 0
    s_add_u32 s50, s48, s49
    s_waitcnt vmcnt(6)
    buffer_load_dwordx4 v2, s[40:43], s50 offen offset:0 nt lds
    s_waitcnt lgkmcnt(0)
    v_mfma_f32_16x16x32_bf16 v[128:131], v[32:35], v[16:19], 0
    v_mfma_f32_16x16x32_bf16 v[128:131], v[36:39], v[20:23], v[128:131]
    s_waitcnt vmcnt(6)
    buffer_load_dwordx4 v3, s[40:43], s50 offen offset:1024 nt lds
    v_mfma_f32_16x16x32_bf16 v[128:131], v[40:43], v[24:27], v[128:131]
    v_mfma_f32_16x16x32_bf16 v[128:131], v[44:47], v[28:31], v[128:131]
    s_waitcnt vmcnt(6)
    buffer_load_dwordx4 v2, s[40:43], s50 offen offset:2048 nt lds
    s_waitcnt vmcnt(6)
    buffer_load_dwordx4 v3, s[40:43], s50 offen offset:3072 nt lds
    s_add_u32 s49, s49, 0x4000
    s_and_b32 s49, s49, 0x3ffff
    ds_read_b128 v[32:35], v4 offset:20480
    ds_read_b128 v[36:39], v5 offset:20480
    ds_read_b128 v[40:43], v6 offset:20480
    ds_read_b128 v[44:47], v7 offset:20480
    v_max3_f32 v196, v124, v125, v196
    v_max3_f32 v196, v126, v127, v196
    s_add_u32 m0, s51, 4096
    s_add_u32 s50, s48, s49
    s_waitcnt vmcnt(6)
    buffer_load_dwordx4 v2, s[40:43], s50 offen offset:0 nt lds
    s_waitcnt lgkmcnt(0)
    v_mfma_f32_16x16x32_bf16 v[132:135], v[32:35], v[16:19], 0
    v_mfma_f32_16x16x32_bf16 v[132:135], v[36:39], v[20:23], v[132:135]
    s_waitcnt vmcnt(6)
    buffer_load_dwordx4 v3, s[40:43], s50 offen offset:1024 nt lds
    v_mfma_f32_16x16x32_bf16 v[132:135], v[40:43], v[24:27], v[132:135]
    v_mfma_f32_16x16x32_bf16 v[132:135], v[44:47], v[28:31], v[132:135]
    s_waitcnt vmcnt(6)
    buffer_load_dwordx4 v2, s[40:43], s50 offen offset:2048 nt lds
    s_waitcnt vmcnt(6)
    buffer_load_dwordx4 v3, s[40:43], s50 offen offset:3072 nt lds
    s_add_u32 s49, s49, 0x4000
    s_and_b32 s49, s49, 0x3ffff
    ds_read_b128 v[32:35], v4 offset:24576
    ds_read_b128 v[36:39], v5 offset:24576
    ds_read_b128 v[40:43], v6 offset:24576
    ds_read_b128 v[44:47], v7 offset:24576
    v_max3_f32 v196, v128, v129, v196
    v_max3_f32 v196, v130, v131, v196
    s_add_u32 m0, s51, 8192
    s_add_u32 s50, s48, s49
    s_waitcnt vmcnt(6)
    buffer_load_dwordx4 v2, s[40:43], s50 offen offset:0 nt lds
    s_waitcnt lgkmcnt(0)
    v_mfma_f32_16x16x32_bf16 v[136:139], v[32:35], v[16:19], 0
    v_mfma_f32_16x16x32_bf16 v[136:139], v[36:39], v[20:23], v[136:139]
    s_waitcnt vmcnt(6)
    buffer_load_dwordx4 v3, s[40:43], s50 offen offset:1024 nt lds
    v_mfma_f32_16x16x32_bf16 v[136:139], v[40:43], v[24:27], v[136:139]
    v_mfma_f32_16x16x32_bf16 v[136:139], v[44:47], v[28:31], v[136:139]
    s_waitcnt vmcnt(6)
    buffer_load_dwordx4 v2, s[40:43], s50 offen offset:2048 nt lds
    s_waitcnt vmcnt(6)
    buffer_load_dwordx4 v3, s[40:43], s50 offen offset:3072 nt lds
    s_add_u32 s49, s49, 0x4000
    s_and_b32 s49, s49, 0x3ffff
    ds_read_b128 v[32:35], v4 offset:28672
    ds_read_b128 v[36:39], v5 offset:28672
    ds_read_b128 v[40:43], v6 offset:28672
    ds_read_b128 v[44:47], v7 offset:28672
    v_max3_f32 v196, v132, v133, v196
    v_max3_f32 v196, v134, v135, v196
    s_add_u32 m0, s51, 12288
    s_add_u32 s50, s48, s49
    s_waitcnt vmcnt(6)
    buffer_load_dwordx4 v2, s[40:43], s50 offen offset:0 nt lds
    s_waitcnt lgkmcnt(0)
    v_mfma_f32_16x16x32_bf16 v[140:143], v[32:35], v[16:19], 0
    v_mfma_f32_16x16x32_bf16 v[140:143], v[36:39], v[20:23], v[140:143]
    s_waitcnt vmcnt(6)
    buffer_load_dwordx4 v3, s[40:43], s50 offen offset:1024 nt lds
    v_mfma_f32_16x16x32_bf16 v[140:143], v[40:43], v[24:27], v[140:143]
    v_mfma_f32_16x16x32_bf16 v[140:143], v[44:47], v[28:31], v[140:143]
    s_waitcnt vmcnt(6)
    buffer_load_dwordx4 v2, s[40:43], s50 offen offset:2048 nt lds
    s_waitcnt vmcnt(6)
    buffer_load_dwordx4 v3, s[40:43], s50 offen offset:3072 nt lds
    s_add_u32 s49, s49, 0x4000
    s_and_b32 s49, s49, 0x3ffff
    v_max3_f32 v196, v136, v137, v196
    v_max3_f32 v196, v138, v139, v196
    v_max3_f32 v196, v140, v141, v196
    v_max3_f32 v196, v142, v143, v196
    v_mov_b32 v198, v196
    s_nop 1
    v_permlane16_swap_b32 v196, v198
    v_max_f32 v196, v196, v198
    v_mov_b32 v198, v196
    s_nop 1
    v_permlane32_swap_b32 v196, v198
    v_max_f32 v196, v196, v198
    v_mul_f32 v197, s52, v196
    v_and_b32 v197, s54, v197
    v_and_b32 v198, 3, v1
    v_lshlrev_b32 v198, 4, v198
    s_lshl_b32 s86, s28, 2
    s_add_u32 s86, s86, 151552
    v_add_u32 v198, s86, v198
    ds_write_b32 v198, v197
    v_fma_f32 v188, v80, s52, -v197
    v_fma_f32 v189, v81, s52, -v197
    v_fma_f32 v190, v82, s52, -v197
    v_fma_f32 v191, v83, s52, -v197
    v_fma_f32 v192, v84, s52, -v197
    v_fma_f32 v193, v85, s52, -v197
    v_fma_f32 v194, v86, s52, -v197
    v_fma_f32 v195, v87, s52, -v197
    v_exp_f32 v188, v188
    v_exp_f32 v189, v189
    v_exp_f32 v190, v190
    v_exp_f32 v191, v191
    v_exp_f32 v192, v192
    v_exp_f32 v193, v193
    v_exp_f32 v194, v194
    v_exp_f32 v195, v195
    s_nop 0
    s_nop 0
    v_cvt_pk_bf16_f32 v180, v188, v189
    v_cvt_pk_bf16_f32 v181, v190, v191
    v_cvt_pk_bf16_f32 v182, v192, v193
    v_cvt_pk_bf16_f32 v183, v194, v195
    s_mov_b64 s[88:89], s[58:59]
    v_cndmask_b32 v152, 0, v180, s[88:89]
    v_cndmask_b32 v153, 0, v181, s[88:89]
    v_cndmask_b32 v154, 0, v182, s[88:89]
    v_cndmask_b32 v155, 0, v183, s[88:89]
    s_lshl_b64 s[88:89], s[88:89], 4
    v_cndmask_b32 v156, 0, v180, s[88:89]
    v_cndmask_b32 v157, 0, v181, s[88:89]
    v_cndmask_b32 v158, 0, v182, s[88:89]
    v_cndmask_b32 v159, 0, v183, s[88:89]
    s_lshl_b64 s[88:89], s[88:89], 4
    v_cndmask_b32 v160, 0, v180, s[88:89]
    v_cndmask_b32 v161, 0, v181, s[88:89]
    v_cndmask_b32 v162, 0, v182, s[88:89]
    v_cndmask_b32 v163, 0, v183, s[88:89]
    s_lshl_b64 s[88:89], s[88:89], 4
    v_cndmask_b32 v164, 0, v180, s[88:89]
    v_cndmask_b32 v165, 0, v181, s[88:89]
    v_cndmask_b32 v166, 0, v182, s[88:89]
    v_cndmask_b32 v167, 0, v183, s[88:89]
    ds_read_b64_tr_b16 v[48:49], v8 offset:0
    ds_read_b64_tr_b16 v[50:51], v8 offset:4096
    ds_read_b64_tr_b16 v[52:53], v9 offset:0
    ds_read_b64_tr_b16 v[54:55], v9 offset:4096
    s_add_u32 m0, s51, 16384
    s_add_u32 s50, s48, s49
    s_waitcnt vmcnt(6)
    buffer_load_dwordx4 v2, s[40:43], s50 offen offset:0 nt lds
    ds_read_b64_tr_b16 v[56:57], v10 offset:0
    ds_read_b64_tr_b16 v[58:59], v10 offset:4096
    ds_read_b64_tr_b16 v[60:61], v11 offset:0
    ds_read_b64_tr_b16 v[62:63], v11 offset:4096
    ds_read_b64_tr_b16 v[64:65], v12 offset:0
    ds_read_b64_tr_b16 v[66:67], v12 offset:4096
    s_waitcnt vmcnt(6)
    buffer_load_dwordx4 v3, s[40:43], s50 offen offset:1024 nt lds
    ds_read_b64_tr_b16 v[68:69], v13 offset:0
    ds_read_b64_tr_b16 v[70:71], v13 offset:4096
    ds_read_b64_tr_b16 v[72:73], v14 offset:0
    ds_read_b64_tr_b16 v[74:75], v14 offset:4096
    s_waitcnt lgkmcnt(6)
    v_mfma_f32_16x16x32_bf16 v[144:147], v[48:51], v[152:155], 0
    ds_read_b64_tr_b16 v[76:77], v15 offset:0
    ds_read_b64_tr_b16 v[78:79], v15 offset:4096
    v_mfma_f32_16x16x32_bf16 v[144:147], v[52:55], v[156:159], v[144:147]
    s_waitcnt vmcnt(6)
    buffer_load_dwordx4 v2, s[40:43], s50 offen offset:2048 nt lds
    v_mfma_f32_16x16x32_bf16 v[144:147], v[56:59], v[160:163], v[144:147]
    v_mfma_f32_16x16x32_bf16 v[144:147], v[60:63], v[164:167], v[144:147]
    s_waitcnt vmcnt(6)
    buffer_load_dwordx4 v3, s[40:43], s50 offen offset:3072 nt lds
    s_add_u32 s49, s49, 0x4000
    s_and_b32 s49, s49, 0x3ffff
    s_waitcnt lgkmcnt(0)
    v_mfma_f32_16x16x32_bf16 v[148:151], v[64:67], v[152:155], 0
    v_mfma_f32_16x16x32_bf16 v[148:151], v[68:71], v[156:159], v[148:151]
    s_add_u32 m0, s51, 20480
    s_add_u32 s50, s48, s49
    s_waitcnt vmcnt(6)
    buffer_load_dwordx4 v2, s[40:43], s50 offen offset:0 nt lds
    v_mfma_f32_16x16x32_bf16 v[148:151], v[72:75], v[160:163], v[148:151]
    v_mfma_f32_16x16x32_bf16 v[148:151], v[76:79], v[164:167], v[148:151]
    v_mfma_f32_16x16x32_bf16 v[176:179], v[204:207], v[180:183], 0
    s_waitcnt vmcnt(6)
    buffer_load_dwordx4 v3, s[40:43], s50 offen offset:1024 nt lds
    v_fma_f32 v188, v88, s52, -v197
    v_fma_f32 v189, v89, s52, -v197
    v_fma_f32 v190, v90, s52, -v197
    v_fma_f32 v191, v91, s52, -v197
    v_fma_f32 v192, v92, s52, -v197
    v_fma_f32 v193, v93, s52, -v197
    v_fma_f32 v194, v94, s52, -v197
    v_fma_f32 v195, v95, s52, -v197
    s_waitcnt vmcnt(6)
    buffer_load_dwordx4 v2, s[40:43], s50 offen offset:2048 nt lds
    v_exp_f32 v188, v188
    v_exp_f32 v189, v189
    v_exp_f32 v190, v190
    v_exp_f32 v191, v191
    v_exp_f32 v192, v192
    v_exp_f32 v193, v193
    v_exp_f32 v194, v194
    v_exp_f32 v195, v195
    s_waitcnt vmcnt(6)
    buffer_load_dwordx4 v3, s[40:43], s50 offen offset:3072 nt lds
    s_add_u32 s49, s49, 0x4000
    s_and_b32 s49, s49, 0x3ffff
    s_nop 0
    v_cvt_pk_bf16_f32 v184, v188, v189
    v_cvt_pk_bf16_f32 v185, v190, v191
    v_cvt_pk_bf16_f32 v186, v192, v193
    v_cvt_pk_bf16_f32 v187, v194, v195
    s_mov_b64 s[88:89], s[58:59]
    v_cndmask_b32 v32, 0, v184, s[88:89]
    v_cndmask_b32 v33, 0, v185, s[88:89]
    v_cndmask_b32 v34, 0, v186, s[88:89]
    v_cndmask_b32 v35, 0, v187, s[88:89]
    s_lshl_b64 s[88:89], s[88:89], 4
    v_cndmask_b32 v36, 0, v184, s[88:89]
    v_cndmask_b32 v37, 0, v185, s[88:89]
    v_cndmask_b32 v38, 0, v186, s[88:89]
    v_cndmask_b32 v39, 0, v187, s[88:89]
    s_lshl_b64 s[88:89], s[88:89], 4
    v_cndmask_b32 v40, 0, v184, s[88:89]
    v_cndmask_b32 v41, 0, v185, s[88:89]
    v_cndmask_b32 v42, 0, v186, s[88:89]
    v_cndmask_b32 v43, 0, v187, s[88:89]
    s_lshl_b64 s[88:89], s[88:89], 4
    v_cndmask_b32 v44, 0, v184, s[88:89]
    v_cndmask_b32 v45, 0, v185, s[88:89]
    v_cndmask_b32 v46, 0, v186, s[88:89]
    v_cndmask_b32 v47, 0, v187, s[88:89]
    ds_read_b64_tr_b16 v[48:49], v8 offset:8192
    ds_read_b64_tr_b16 v[50:51], v8 offset:12288
    ds_read_b64_tr_b16 v[52:53], v9 offset:8192
    ds_read_b64_tr_b16 v[54:55], v9 offset:12288
    s_add_u32 m0, s51, 0
    s_add_u32 s50, s48, s49
    s_waitcnt vmcnt(6)
    buffer_load_dwordx4 v2, s[40:43], s50 offen offset:0 nt lds
    ds_read_b64_tr_b16 v[56:57], v10 offset:8192
    ds_read_b64_tr_b16 v[58:59], v10 offset:12288
    ds_read_b64_tr_b16 v[60:61], v11 offset:8192
    ds_read_b64_tr_b16 v[62:63], v11 offset:12288
    ds_read_b64_tr_b16 v[64:65], v12 offset:8192
    ds_read_b64_tr_b16 v[66:67], v12 offset:12288
    s_waitcnt vmcnt(6)
    buffer_load_dwordx4 v3, s[40:43], s50 offen offset:1024 nt lds
    ds_read_b64_tr_b16 v[68:69], v13 offset:8192
    ds_read_b64_tr_b16 v[70:71], v13 offset:12288
    ds_read_b64_tr_b16 v[72:73], v14 offset:8192
    ds_read_b64_tr_b16 v[74:75], v14 offset:12288
    s_waitcnt lgkmcnt(6)
    v_mfma_f32_16x16x32_bf16 v[144:147], v[48:51], v[32:35], v[144:147]
    ds_read_b64_tr_b16 v[76:77], v15 offset:8192
    ds_read_b64_tr_b16 v[78:79], v15 offset:12288
    v_mfma_f32_16x16x32_bf16 v[144:147], v[52:55], v[36:39], v[144:147]
    s_waitcnt vmcnt(6)
    buffer_load_dwordx4 v2, s[40:43], s50 offen offset:2048 nt lds
    v_mfma_f32_16x16x32_bf16 v[144:147], v[56:59], v[40:43], v[144:147]
    v_mfma_f32_16x16x32_bf16 v[144:147], v[60:63], v[44:47], v[144:147]
    s_waitcnt vmcnt(6)
    buffer_load_dwordx4 v3, s[40:43], s50 offen offset:3072 nt lds
    s_add_u32 s49, s49, 0x4000
    s_and_b32 s49, s49, 0x3ffff
    s_waitcnt lgkmcnt(0)
    v_mfma_f32_16x16x32_bf16 v[148:151], v[64:67], v[32:35], v[148:151]
    v_mfma_f32_16x16x32_bf16 v[148:151], v[68:71], v[36:39], v[148:151]
    s_add_u32 m0, s51, 4096
    s_add_u32 s50, s48, s49
    s_waitcnt vmcnt(6)
    buffer_load_dwordx4 v2, s[40:43], s50 offen offset:0 nt lds
    v_mfma_f32_16x16x32_bf16 v[148:151], v[72:75], v[40:43], v[148:151]
    v_mfma_f32_16x16x32_bf16 v[148:151], v[76:79], v[44:47], v[148:151]
    v_mfma_f32_16x16x32_bf16 v[176:179], v[204:207], v[184:187], v[176:179]
    s_waitcnt vmcnt(6)
    buffer_load_dwordx4 v3, s[40:43], s50 offen offset:1024 nt lds
    v_fma_f32 v188, v96, s52, -v197
    v_fma_f32 v189, v97, s52, -v197
    v_fma_f32 v190, v98, s52, -v197
    v_fma_f32 v191, v99, s52, -v197
    v_fma_f32 v192, v100, s52, -v197
    v_fma_f32 v193, v101, s52, -v197
    v_fma_f32 v194, v102, s52, -v197
    v_fma_f32 v195, v103, s52, -v197
    s_waitcnt vmcnt(6)
    buffer_load_dwordx4 v2, s[40:43], s50 offen offset:2048 nt lds
    v_exp_f32 v188, v188
    v_exp_f32 v189, v189
    v_exp_f32 v190, v190
    v_exp_f32 v191, v191
    v_exp_f32 v192, v192
    v_exp_f32 v193, v193
    v_exp_f32 v194, v194
    v_exp_f32 v195, v195
    s_waitcnt vmcnt(6)
    buffer_load_dwordx4 v3, s[40:43], s50 offen offset:3072 nt lds
    s_add_u32 s49, s49, 0x4000
    s_and_b32 s49, s49, 0x3ffff
    s_nop 0
    v_cvt_pk_bf16_f32 v180, v188, v189
    v_cvt_pk_bf16_f32 v181, v190, v191
    v_cvt_pk_bf16_f32 v182, v192, v193
    v_cvt_pk_bf16_f32 v183, v194, v195
    s_mov_b64 s[88:89], s[58:59]
    v_cndmask_b32 v152, 0, v180, s[88:89]
    v_cndmask_b32 v153, 0, v181, s[88:89]
    v_cndmask_b32 v154, 0, v182, s[88:89]
    v_cndmask_b32 v155, 0, v183, s[88:89]
    s_lshl_b64 s[88:89], s[88:89], 4
    v_cndmask_b32 v156, 0, v180, s[88:89]
    v_cndmask_b32 v157, 0, v181, s[88:89]
    v_cndmask_b32 v158, 0, v182, s[88:89]
    v_cndmask_b32 v159, 0, v183, s[88:89]
    s_lshl_b64 s[88:89], s[88:89], 4
    v_cndmask_b32 v160, 0, v180, s[88:89]
    v_cndmask_b32 v161, 0, v181, s[88:89]
    v_cndmask_b32 v162, 0, v182, s[88:89]
    v_cndmask_b32 v163, 0, v183, s[88:89]
    s_lshl_b64 s[88:89], s[88:89], 4
    v_cndmask_b32 v164, 0, v180, s[88:89]
    v_cndmask_b32 v165, 0, v181, s[88:89]
    v_cndmask_b32 v166, 0, v182, s[88:89]
    v_cndmask_b32 v167, 0, v183, s[88:89]
    ds_read_b64_tr_b16 v[48:49], v8 offset:16384
    ds_read_b64_tr_b16 v[50:51], v8 offset:20480
    ds_read_b64_tr_b16 v[52:53], v9 offset:16384
    ds_read_b64_tr_b16 v[54:55], v9 offset:20480
    s_add_u32 m0, s51, 8192
    s_add_u32 s50, s48, s49
    s_waitcnt vmcnt(6)
    buffer_load_dwordx4 v2, s[40:43], s50 offen offset:0 nt lds
    ds_read_b64_tr_b16 v[56:57], v10 offset:16384
    ds_read_b64_tr_b16 v[58:59], v10 offset:20480
    ds_read_b64_tr_b16 v[60:61], v11 offset:16384
    ds_read_b64_tr_b16 v[62:63], v11 offset:20480
    ds_read_b64_tr_b16 v[64:65], v12 offset:16384
    ds_read_b64_tr_b16 v[66:67], v12 offset:20480
    s_waitcnt vmcnt(6)
    buffer_load_dwordx4 v3, s[40:43], s50 offen offset:1024 nt lds
    ds_read_b64_tr_b16 v[68:69], v13 offset:16384
    ds_read_b64_tr_b16 v[70:71], v13 offset:20480
    ds_read_b64_tr_b16 v[72:73], v14 offset:16384
    ds_read_b64_tr_b16 v[74:75], v14 offset:20480
    s_waitcnt lgkmcnt(6)
    v_mfma_f32_16x16x32_bf16 v[144:147], v[48:51], v[152:155], v[144:147]
    ds_read_b64_tr_b16 v[76:77], v15 offset:16384
    ds_read_b64_tr_b16 v[78:79], v15 offset:20480
    v_mfma_f32_16x16x32_bf16 v[144:147], v[52:55], v[156:159], v[144:147]
    s_waitcnt vmcnt(6)
    buffer_load_dwordx4 v2, s[40:43], s50 offen offset:2048 nt lds
    v_mfma_f32_16x16x32_bf16 v[144:147], v[56:59], v[160:163], v[144:147]
    v_mfma_f32_16x16x32_bf16 v[144:147], v[60:63], v[164:167], v[144:147]
    s_waitcnt vmcnt(6)
    buffer_load_dwordx4 v3, s[40:43], s50 offen offset:3072 nt lds
    s_add_u32 s49, s49, 0x4000
    s_and_b32 s49, s49, 0x3ffff
    s_waitcnt lgkmcnt(0)
    v_mfma_f32_16x16x32_bf16 v[148:151], v[64:67], v[152:155], v[148:151]
    v_mfma_f32_16x16x32_bf16 v[148:151], v[68:71], v[156:159], v[148:151]
    s_add_u32 m0, s51, 12288
    s_add_u32 s50, s48, s49
    s_waitcnt vmcnt(6)
    buffer_load_dwordx4 v2, s[40:43], s50 offen offset:0 nt lds
    v_mfma_f32_16x16x32_bf16 v[148:151], v[72:75], v[160:163], v[148:151]
    v_mfma_f32_16x16x32_bf16 v[148:151], v[76:79], v[164:167], v[148:151]
    v_mfma_f32_16x16x32_bf16 v[176:179], v[204:207], v[180:183], v[176:179]
    s_waitcnt vmcnt(6)
    buffer_load_dwordx4 v3, s[40:43], s50 offen offset:1024 nt lds
    v_fma_f32 v188, v104, s52, -v197
    v_fma_f32 v189, v105, s52, -v197
    v_fma_f32 v190, v106, s52, -v197
    v_fma_f32 v191, v107, s52, -v197
    v_fma_f32 v192, v108, s52, -v197
    v_fma_f32 v193, v109, s52, -v197
    v_fma_f32 v194, v110, s52, -v197
    v_fma_f32 v195, v111, s52, -v197
    s_waitcnt vmcnt(6)
    buffer_load_dwordx4 v2, s[40:43], s50 offen offset:2048 nt lds
    v_exp_f32 v188, v188
    v_exp_f32 v189, v189
    v_exp_f32 v190, v190
    v_exp_f32 v191, v191
    v_exp_f32 v192, v192
    v_exp_f32 v193, v193
    v_exp_f32 v194, v194
    v_exp_f32 v195, v195
    s_waitcnt vmcnt(6)
    buffer_load_dwordx4 v3, s[40:43], s50 offen offset:3072 nt lds
    s_add_u32 s49, s49, 0x4000
    s_and_b32 s49, s49, 0x3ffff
    s_nop 0
    v_cvt_pk_bf16_f32 v184, v188, v189
    v_cvt_pk_bf16_f32 v185, v190, v191
    v_cvt_pk_bf16_f32 v186, v192, v193
    v_cvt_pk_bf16_f32 v187, v194, v195
    s_mov_b64 s[88:89], s[58:59]
    v_cndmask_b32 v32, 0, v184, s[88:89]
    v_cndmask_b32 v33, 0, v185, s[88:89]
    v_cndmask_b32 v34, 0, v186, s[88:89]
    v_cndmask_b32 v35, 0, v187, s[88:89]
    s_lshl_b64 s[88:89], s[88:89], 4
    v_cndmask_b32 v36, 0, v184, s[88:89]
    v_cndmask_b32 v37, 0, v185, s[88:89]
    v_cndmask_b32 v38, 0, v186, s[88:89]
    v_cndmask_b32 v39, 0, v187, s[88:89]
    s_lshl_b64 s[88:89], s[88:89], 4
    v_cndmask_b32 v40, 0, v184, s[88:89]
    v_cndmask_b32 v41, 0, v185, s[88:89]
    v_cndmask_b32 v42, 0, v186, s[88:89]
    v_cndmask_b32 v43, 0, v187, s[88:89]
    s_lshl_b64 s[88:89], s[88:89], 4
    v_cndmask_b32 v44, 0, v184, s[88:89]
    v_cndmask_b32 v45, 0, v185, s[88:89]
    v_cndmask_b32 v46, 0, v186, s[88:89]
    v_cndmask_b32 v47, 0, v187, s[88:89]
    ds_read_b64_tr_b16 v[48:49], v8 offset:0
    ds_read_b64_tr_b16 v[50:51], v8 offset:4096
    ds_read_b64_tr_b16 v[52:53], v9 offset:0
    ds_read_b64_tr_b16 v[54:55], v9 offset:4096
    s_add_u32 m0, s51, 16384
    s_add_u32 s50, s48, s49
    s_waitcnt vmcnt(6)
    buffer_load_dwordx4 v2, s[40:43], s50 offen offset:0 nt lds
    ds_read_b64_tr_b16 v[56:57], v10 offset:0
    ds_read_b64_tr_b16 v[58:59], v10 offset:4096
    ds_read_b64_tr_b16 v[60:61], v11 offset:0
    ds_read_b64_tr_b16 v[62:63], v11 offset:4096
    ds_read_b64_tr_b16 v[64:65], v12 offset:0
    ds_read_b64_tr_b16 v[66:67], v12 offset:4096
    s_waitcnt vmcnt(6)
    buffer_load_dwordx4 v3, s[40:43], s50 offen offset:1024 nt lds
    ds_read_b64_tr_b16 v[68:69], v13 offset:0
    ds_read_b64_tr_b16 v[70:71], v13 offset:4096
    ds_read_b64_tr_b16 v[72:73], v14 offset:0
    ds_read_b64_tr_b16 v[74:75], v14 offset:4096
    s_waitcnt lgkmcnt(6)
    v_mfma_f32_16x16x32_bf16 v[144:147], v[48:51], v[32:35], v[144:147]
    ds_read_b64_tr_b16 v[76:77], v15 offset:0
    ds_read_b64_tr_b16 v[78:79], v15 offset:4096
    v_mfma_f32_16x16x32_bf16 v[144:147], v[52:55], v[36:39], v[144:147]
    s_waitcnt vmcnt(6)
    buffer_load_dwordx4 v2, s[40:43], s50 offen offset:2048 nt lds
    v_mfma_f32_16x16x32_bf16 v[144:147], v[56:59], v[40:43], v[144:147]
    v_mfma_f32_16x16x32_bf16 v[144:147], v[60:63], v[44:47], v[144:147]
    s_waitcnt vmcnt(6)
    buffer_load_dwordx4 v3, s[40:43], s50 offen offset:3072 nt lds
    s_add_u32 s49, s49, 0x4000
    s_and_b32 s49, s49, 0x3ffff
    s_waitcnt lgkmcnt(0)
    v_mfma_f32_16x16x32_bf16 v[148:151], v[64:67], v[32:35], v[148:151]
    v_mfma_f32_16x16x32_bf16 v[148:151], v[68:71], v[36:39], v[148:151]
    s_add_u32 m0, s51, 20480
    s_add_u32 s50, s48, s49
    s_waitcnt vmcnt(6)
    buffer_load_dwordx4 v2, s[40:43], s50 offen offset:0 nt lds
    v_mfma_f32_16x16x32_bf16 v[148:151], v[72:75], v[40:43], v[148:151]
    v_mfma_f32_16x16x32_bf16 v[148:151], v[76:79], v[44:47], v[148:151]
    v_mfma_f32_16x16x32_bf16 v[176:179], v[204:207], v[184:187], v[176:179]
    s_waitcnt vmcnt(6)
    buffer_load_dwordx4 v3, s[40:43], s50 offen offset:1024 nt lds
    v_fma_f32 v188, v112, s52, -v197
    v_fma_f32 v189, v113, s52, -v197
    v_fma_f32 v190, v114, s52, -v197
    v_fma_f32 v191, v115, s52, -v197
    v_fma_f32 v192, v116, s52, -v197
    v_fma_f32 v193, v117, s52, -v197
    v_fma_f32 v194, v118, s52, -v197
    v_fma_f32 v195, v119, s52, -v197
    s_waitcnt vmcnt(6)
    buffer_load_dwordx4 v2, s[40:43], s50 offen offset:2048 nt lds
    v_exp_f32 v188, v188
    v_exp_f32 v189, v189
    v_exp_f32 v190, v190
    v_exp_f32 v191, v191
    v_exp_f32 v192, v192
    v_exp_f32 v193, v193
    v_exp_f32 v194, v194
    v_exp_f32 v195, v195
    s_waitcnt vmcnt(6)
    buffer_load_dwordx4 v3, s[40:43], s50 offen offset:3072 nt lds
    s_add_u32 s49, s49, 0x4000
    s_and_b32 s49, s49, 0x3ffff
    s_nop 0
    v_cvt_pk_bf16_f32 v180, v188, v189
    v_cvt_pk_bf16_f32 v181, v190, v191
    v_cvt_pk_bf16_f32 v182, v192, v193
    v_cvt_pk_bf16_f32 v183, v194, v195
    s_mov_b64 s[88:89], s[58:59]
    v_cndmask_b32 v152, 0, v180, s[88:89]
    v_cndmask_b32 v153, 0, v181, s[88:89]
    v_cndmask_b32 v154, 0, v182, s[88:89]
    v_cndmask_b32 v155, 0, v183, s[88:89]
    s_lshl_b64 s[88:89], s[88:89], 4
    v_cndmask_b32 v156, 0, v180, s[88:89]
    v_cndmask_b32 v157, 0, v181, s[88:89]
    v_cndmask_b32 v158, 0, v182, s[88:89]
    v_cndmask_b32 v159, 0, v183, s[88:89]
    s_lshl_b64 s[88:89], s[88:89], 4
    v_cndmask_b32 v160, 0, v180, s[88:89]
    v_cndmask_b32 v161, 0, v181, s[88:89]
    v_cndmask_b32 v162, 0, v182, s[88:89]
    v_cndmask_b32 v163, 0, v183, s[88:89]
    s_lshl_b64 s[88:89], s[88:89], 4
    v_cndmask_b32 v164, 0, v180, s[88:89]
    v_cndmask_b32 v165, 0, v181, s[88:89]
    v_cndmask_b32 v166, 0, v182, s[88:89]
    v_cndmask_b32 v167, 0, v183, s[88:89]
    ds_read_b64_tr_b16 v[48:49], v8 offset:8192
    ds_read_b64_tr_b16 v[50:51], v8 offset:12288
    ds_read_b64_tr_b16 v[52:53], v9 offset:8192
    ds_read_b64_tr_b16 v[54:55], v9 offset:12288
    s_add_u32 m0, s51, 0
    s_add_u32 s50, s48, s49
    s_waitcnt vmcnt(6)
    buffer_load_dwordx4 v2, s[40:43], s50 offen offset:0 nt lds
    ds_read_b64_tr_b16 v[56:57], v10 offset:8192
    ds_read_b64_tr_b16 v[58:59], v10 offset:12288
    ds_read_b64_tr_b16 v[60:61], v11 offset:8192
    ds_read_b64_tr_b16 v[62:63], v11 offset:12288
    ds_read_b64_tr_b16 v[64:65], v12 offset:8192
    ds_read_b64_tr_b16 v[66:67], v12 offset:12288
    s_waitcnt vmcnt(6)
    buffer_load_dwordx4 v3, s[40:43], s50 offen offset:1024 nt lds
    ds_read_b64_tr_b16 v[68:69], v13 offset:8192
    ds_read_b64_tr_b16 v[70:71], v13 offset:12288
    ds_read_b64_tr_b16 v[72:73], v14 offset:8192
    ds_read_b64_tr_b16 v[74:75], v14 offset:12288
    s_waitcnt lgkmcnt(6)
    v_mfma_f32_16x16x32_bf16 v[144:147], v[48:51], v[152:155], v[144:147]
    ds_read_b64_tr_b16 v[76:77], v15 offset:8192
    ds_read_b64_tr_b16 v[78:79], v15 offset:12288
    v_mfma_f32_16x16x32_bf16 v[144:147], v[52:55], v[156:159], v[144:147]
    s_waitcnt vmcnt(6)
    buffer_load_dwordx4 v2, s[40:43], s50 offen offset:2048 nt lds
    v_mfma_f32_16x16x32_bf16 v[144:147], v[56:59], v[160:163], v[144:147]
    v_mfma_f32_16x16x32_bf16 v[144:147], v[60:63], v[164:167], v[144:147]
    s_waitcnt vmcnt(6)
    buffer_load_dwordx4 v3, s[40:43], s50 offen offset:3072 nt lds
    s_add_u32 s49, s49, 0x4000
    s_and_b32 s49, s49, 0x3ffff
    s_waitcnt lgkmcnt(0)
    v_mfma_f32_16x16x32_bf16 v[148:151], v[64:67], v[152:155], v[148:151]
    v_mfma_f32_16x16x32_bf16 v[148:151], v[68:71], v[156:159], v[148:151]
    s_add_u32 m0, s51, 4096
    s_add_u32 s50, s48, s49
    s_waitcnt vmcnt(6)
    buffer_load_dwordx4 v2, s[40:43], s50 offen offset:0 nt lds
    v_mfma_f32_16x16x32_bf16 v[148:151], v[72:75], v[160:163], v[148:151]
    v_mfma_f32_16x16x32_bf16 v[148:151], v[76:79], v[164:167], v[148:151]
    v_mfma_f32_16x16x32_bf16 v[176:179], v[204:207], v[180:183], v[176:179]
    s_waitcnt vmcnt(6)
    buffer_load_dwordx4 v3, s[40:43], s50 offen offset:1024 nt lds
    v_fma_f32 v188, v120, s52, -v197
    v_fma_f32 v189, v121, s52, -v197
    v_fma_f32 v190, v122, s52, -v197
    v_fma_f32 v191, v123, s52, -v197
    v_fma_f32 v192, v124, s52, -v197
    v_fma_f32 v193, v125, s52, -v197
    v_fma_f32 v194, v126, s52, -v197
    v_fma_f32 v195, v127, s52, -v197
    s_waitcnt vmcnt(6)
    buffer_load_dwordx4 v2, s[40:43], s50 offen offset:2048 nt lds
    v_exp_f32 v188, v188
    v_exp_f32 v189, v189
    v_exp_f32 v190, v190
    v_exp_f32 v191, v191
    v_exp_f32 v192, v192
    v_exp_f32 v193, v193
    v_exp_f32 v194, v194
    v_exp_f32 v195, v195
    s_waitcnt vmcnt(6)
    buffer_load_dwordx4 v3, s[40:43], s50 offen offset:3072 nt lds
    s_add_u32 s49, s49, 0x4000
    s_and_b32 s49, s49, 0x3ffff
    s_nop 0
    v_cvt_pk_bf16_f32 v184, v188, v189
    v_cvt_pk_bf16_f32 v185, v190, v191
    v_cvt_pk_bf16_f32 v186, v192, v193
    v_cvt_pk_bf16_f32 v187, v194, v195
    s_mov_b64 s[88:89], s[58:59]
    v_cndmask_b32 v32, 0, v184, s[88:89]
    v_cndmask_b32 v33, 0, v185, s[88:89]
    v_cndmask_b32 v34, 0, v186, s[88:89]
    v_cndmask_b32 v35, 0, v187, s[88:89]
    s_lshl_b64 s[88:89], s[88:89], 4
    v_cndmask_b32 v36, 0, v184, s[88:89]
    v_cndmask_b32 v37, 0, v185, s[88:89]
    v_cndmask_b32 v38, 0, v186, s[88:89]
    v_cndmask_b32 v39, 0, v187, s[88:89]
    s_lshl_b64 s[88:89], s[88:89], 4
    v_cndmask_b32 v40, 0, v184, s[88:89]
    v_cndmask_b32 v41, 0, v185, s[88:89]
    v_cndmask_b32 v42, 0, v186, s[88:89]
    v_cndmask_b32 v43, 0, v187, s[88:89]
    s_lshl_b64 s[88:89], s[88:89], 4
    v_cndmask_b32 v44, 0, v184, s[88:89]
    v_cndmask_b32 v45, 0, v185, s[88:89]
    v_cndmask_b32 v46, 0, v186, s[88:89]
    v_cndmask_b32 v47, 0, v187, s[88:89]
    ds_read_b64_tr_b16 v[48:49], v8 offset:16384
    ds_read_b64_tr_b16 v[50:51], v8 offset:20480
    ds_read_b64_tr_b16 v[52:53], v9 offset:16384
    ds_read_b64_tr_b16 v[54:55], v9 offset:20480
    s_add_u32 m0, s51, 8192
    s_add_u32 s50, s48, s49
    s_waitcnt vmcnt(6)
    buffer_load_dwordx4 v2, s[40:43], s50 offen offset:0 nt lds
    ds_read_b64_tr_b16 v[56:57], v10 offset:16384
    ds_read_b64_tr_b16 v[58:59], v10 offset:20480
    ds_read_b64_tr_b16 v[60:61], v11 offset:16384
    ds_read_b64_tr_b16 v[62:63], v11 offset:20480
    ds_read_b64_tr_b16 v[64:65], v12 offset:16384
    ds_read_b64_tr_b16 v[66:67], v12 offset:20480
    s_waitcnt vmcnt(6)
    buffer_load_dwordx4 v3, s[40:43], s50 offen offset:1024 nt lds
    ds_read_b64_tr_b16 v[68:69], v13 offset:16384
    ds_read_b64_tr_b16 v[70:71], v13 offset:20480
    ds_read_b64_tr_b16 v[72:73], v14 offset:16384
    ds_read_b64_tr_b16 v[74:75], v14 offset:20480
    s_waitcnt lgkmcnt(6)
    v_mfma_f32_16x16x32_bf16 v[144:147], v[48:51], v[32:35], v[144:147]
    ds_read_b64_tr_b16 v[76:77], v15 offset:16384
    ds_read_b64_tr_b16 v[78:79], v15 offset:20480
    v_mfma_f32_16x16x32_bf16 v[144:147], v[52:55], v[36:39], v[144:147]
    s_waitcnt vmcnt(6)
    buffer_load_dwordx4 v2, s[40:43], s50 offen offset:2048 nt lds
    v_mfma_f32_16x16x32_bf16 v[144:147], v[56:59], v[40:43], v[144:147]
    v_mfma_f32_16x16x32_bf16 v[144:147], v[60:63], v[44:47], v[144:147]
    s_waitcnt vmcnt(6)
    buffer_load_dwordx4 v3, s[40:43], s50 offen offset:3072 nt lds
    s_add_u32 s49, s49, 0x4000
    s_and_b32 s49, s49, 0x3ffff
    s_waitcnt lgkmcnt(0)
    v_mfma_f32_16x16x32_bf16 v[148:151], v[64:67], v[32:35], v[148:151]
    v_mfma_f32_16x16x32_bf16 v[148:151], v[68:71], v[36:39], v[148:151]
    s_add_u32 m0, s51, 12288
    s_add_u32 s50, s48, s49
    s_waitcnt vmcnt(6)
    buffer_load_dwordx4 v2, s[40:43], s50 offen offset:0 nt lds
    v_mfma_f32_16x16x32_bf16 v[148:151], v[72:75], v[40:43], v[148:151]
    v_mfma_f32_16x16x32_bf16 v[148:151], v[76:79], v[44:47], v[148:151]
    v_mfma_f32_16x16x32_bf16 v[176:179], v[204:207], v[184:187], v[176:179]
    s_waitcnt vmcnt(6)
    buffer_load_dwordx4 v3, s[40:43], s50 offen offset:1024 nt lds
    v_fma_f32 v188, v128, s52, -v197
    v_fma_f32 v189, v129, s52, -v197
    v_fma_f32 v190, v130, s52, -v197
    v_fma_f32 v191, v131, s52, -v197
    v_fma_f32 v192, v132, s52, -v197
    v_fma_f32 v193, v133, s52, -v197
    v_fma_f32 v194, v134, s52, -v197
    v_fma_f32 v195, v135, s52, -v197
    s_waitcnt vmcnt(6)
    buffer_load_dwordx4 v2, s[40:43], s50 offen offset:2048 nt lds
    v_exp_f32 v188, v188
    v_exp_f32 v189, v189
    v_exp_f32 v190, v190
    v_exp_f32 v191, v191
    v_exp_f32 v192, v192
    v_exp_f32 v193, v193
    v_exp_f32 v194, v194
    v_exp_f32 v195, v195
    s_waitcnt vmcnt(6)
    buffer_load_dwordx4 v3, s[40:43], s50 offen offset:3072 nt lds
    s_add_u32 s49, s49, 0x4000
    s_and_b32 s49, s49, 0x3ffff
    s_nop 0
    v_cvt_pk_bf16_f32 v180, v188, v189
    v_cvt_pk_bf16_f32 v181, v190, v191
    v_cvt_pk_bf16_f32 v182, v192, v193
    v_cvt_pk_bf16_f32 v183, v194, v195
    s_mov_b64 s[88:89], s[58:59]
    v_cndmask_b32 v152, 0, v180, s[88:89]
    v_cndmask_b32 v153, 0, v181, s[88:89]
    v_cndmask_b32 v154, 0, v182, s[88:89]
    v_cndmask_b32 v155, 0, v183, s[88:89]
    s_lshl_b64 s[88:89], s[88:89], 4
    v_cndmask_b32 v156, 0, v180, s[88:89]
    v_cndmask_b32 v157, 0, v181, s[88:89]
    v_cndmask_b32 v158, 0, v182, s[88:89]
    v_cndmask_b32 v159, 0, v183, s[88:89]
    s_lshl_b64 s[88:89], s[88:89], 4
    v_cndmask_b32 v160, 0, v180, s[88:89]
    v_cndmask_b32 v161, 0, v181, s[88:89]
    v_cndmask_b32 v162, 0, v182, s[88:89]
    v_cndmask_b32 v163, 0, v183, s[88:89]
    s_lshl_b64 s[88:89], s[88:89], 4
    v_cndmask_b32 v164, 0, v180, s[88:89]
    v_cndmask_b32 v165, 0, v181, s[88:89]
    v_cndmask_b32 v166, 0, v182, s[88:89]
    v_cndmask_b32 v167, 0, v183, s[88:89]
    v_mov_b32 v188, 151688
    v_mov_b32 v189, 1
    s_mov_b64 exec, 1
    ds_add_u32 v188, v189
    s_mov_b64 exec, -1
L_TAIL:
    ds_read_b64_tr_b16 v[48:49], v8 offset:0
    ds_read_b64_tr_b16 v[50:51], v8 offset:4096
    ds_read_b64_tr_b16 v[52:53], v9 offset:0
    ds_read_b64_tr_b16 v[54:55], v9 offset:4096
    ds_read_b64_tr_b16 v[56:57], v10 offset:0
    ds_read_b64_tr_b16 v[58:59], v10 offset:4096
    ds_read_b64_tr_b16 v[60:61], v11 offset:0
    ds_read_b64_tr_b16 v[62:63], v11 offset:4096
    ds_read_b64_tr_b16 v[64:65], v12 offset:0
    ds_read_b64_tr_b16 v[66:67], v12 offset:4096
    ds_read_b64_tr_b16 v[68:69], v13 offset:0
    ds_read_b64_tr_b16 v[70:71], v13 offset:4096
    ds_read_b64_tr_b16 v[72:73], v14 offset:0
    ds_read_b64_tr_b16 v[74:75], v14 offset:4096
    s_waitcnt lgkmcnt(6)
    v_mfma_f32_16x16x32_bf16 v[144:147], v[48:51], v[152:155], v[144:147]
    ds_read_b64_tr_b16 v[76:77], v15 offset:0
    ds_read_b64_tr_b16 v[78:79], v15 offset:4096
    v_mfma_f32_16x16x32_bf16 v[144:147], v[52:55], v[156:159], v[144:147]
    v_mfma_f32_16x16x32_bf16 v[144:147], v[56:59], v[160:163], v[144:147]
    v_mfma_f32_16x16x32_bf16 v[144:147], v[60:63], v[164:167], v[144:147]
    s_waitcnt lgkmcnt(0)
    v_mfma_f32_16x16x32_bf16 v[148:151], v[64:67], v[152:155], v[148:151]
    v_mfma_f32_16x16x32_bf16 v[148:151], v[68:71], v[156:159], v[148:151]
    v_mfma_f32_16x16x32_bf16 v[148:151], v[72:75], v[160:163], v[148:151]
    v_mfma_f32_16x16x32_bf16 v[148:151], v[76:79], v[164:167], v[148:151]
    v_mfma_f32_16x16x32_bf16 v[176:179], v[204:207], v[180:183], v[176:179]
    v_fma_f32 v188, v136, s52, -v197
    v_fma_f32 v189, v137, s52, -v197
    v_fma_f32 v190, v138, s52, -v197
    v_fma_f32 v191, v139, s52, -v197
    v_fma_f32 v192, v140, s52, -v197
    v_fma_f32 v193, v141, s52, -v197
    v_fma_f32 v194, v142, s52, -v197
    v_fma_f32 v195, v143, s52, -v197
    v_exp_f32 v188, v188
    v_exp_f32 v189, v189
    v_exp_f32 v190, v190
    v_exp_f32 v191, v191
    v_exp_f32 v192, v192
    v_exp_f32 v193, v193
    v_exp_f32 v194, v194
    v_exp_f32 v195, v195
    s_nop 0
    s_nop 0
    v_cvt_pk_bf16_f32 v184, v188, v189
    v_cvt_pk_bf16_f32 v185, v190, v191
    v_cvt_pk_bf16_f32 v186, v192, v193
    v_cvt_pk_bf16_f32 v187, v194, v195
    s_mov_b64 s[88:89], s[58:59]
    v_cndmask_b32 v32, 0, v184, s[88:89]
    v_cndmask_b32 v33, 0, v185, s[88:89]
    v_cndmask_b32 v34, 0, v186, s[88:89]
    v_cndmask_b32 v35, 0, v187, s[88:89]
    s_lshl_b64 s[88:89], s[88:89], 4
    v_cndmask_b32 v36, 0, v184, s[88:89]
    v_cndmask_b32 v37, 0, v185, s[88:89]
    v_cndmask_b32 v38, 0, v186, s[88:89]
    v_cndmask_b32 v39, 0, v187, s[88:89]
    s_lshl_b64 s[88:89], s[88:89], 4
    v_cndmask_b32 v40, 0, v184, s[88:89]
    v_cndmask_b32 v41, 0, v185, s[88:89]
    v_cndmask_b32 v42, 0, v186, s[88:89]
    v_cndmask_b32 v43, 0, v187, s[88:89]
    s_lshl_b64 s[88:89], s[88:89], 4
    v_cndmask_b32 v44, 0, v184, s[88:89]
    v_cndmask_b32 v45, 0, v185, s[88:89]
    v_cndmask_b32 v46, 0, v186, s[88:89]
    v_cndmask_b32 v47, 0, v187, s[88:89]
Lm_3:
    ds_read_b128 v[168:171], v222
    s_waitcnt lgkmcnt(0)
    v_cmp_eq_u32 vcc, -1, v168
    v_cmp_eq_u32 s[90:91], -1, v169
    s_or_b64 vcc, vcc, s[90:91]
    v_cmp_eq_u32 s[90:91], -1, v170
    s_or_b64 vcc, vcc, s[90:91]
    v_cmp_eq_u32 s[90:91], -1, v171
    s_or_b64 vcc, vcc, s[90:91]
    s_cbranch_vccz Lmo_4
    s_sub_u32 s55, s55, 1
    s_cbranch_scc0 Lm_3
    s_branch L_END
Lmo_4:
    v_max3_f32 v172, v168, v169, v170
    v_max_f32 v172, v172, v171
    v_sub_f32 v208, v168, v172
    v_sub_f32 v209, v169, v172
    v_sub_f32 v210, v170, v172
    v_sub_f32 v211, v171, v172
    v_exp_f32 v208, v208
    v_exp_f32 v209, v209
    v_exp_f32 v210, v210
    v_exp_f32 v211, v211
    v_bfi_b32 v197, s54, v172, v214
    v_mov_b32 v172, 151688
Lv_5:
    ds_read_b32 v173, v172
    s_waitcnt lgkmcnt(0)
    v_cmp_ne_u32 vcc, 4, v173
    s_cbranch_vccz Lvo_6
    s_sub_u32 s55, s55, 1
    s_cbranch_scc0 Lv_5
    s_branch L_END
Lvo_6:
    s_lshl_b32 s88, s29, 2
    s_add_u32 s88, s88, s94
    s_lshl_b32 s88, s88, 2
    s_add_u32 s88, s88, s28
    s_lshl_b32 s88, s88, 15
    s_lshl_b32 s89, s93, 7
    s_add_u32 s88, s88, s89
    s_cbranch_execz Lz_7
    s_add_u32 m0, s51, 24576
    s_add_u32 s50, s88, 0
    buffer_load_dwordx4 v216, s[44:47], s50 offen nt lds
    s_add_u32 m0, s51, 25600
    s_add_u32 s50, s88, 8192
    buffer_load_dwordx4 v216, s[44:47], s50 offen nt lds
    s_add_u32 m0, s51, 26624
    s_add_u32 s50, s88, 16384
    buffer_load_dwordx4 v216, s[44:47], s50 offen nt lds
    s_add_u32 m0, s51, 27648
    s_add_u32 s50, s88, 24576
    buffer_load_dwordx4 v216, s[44:47], s50 offen nt lds
Lz_7:
    s_lshl_b32 s50, s29, 17
    s_add_u32 s38, s26, 1048576
    s_addc_u32 s39, s27, 0
    s_add_u32 s38, s38, s50
    s_addc_u32 s39, s39, 0
    s_lshl_b32 s88, s30, 12
    s_add_u32 s36, s38, s88
    s_addc_u32 s37, s39, 0
    s_lshr_b32 s88, s28, 1
    s_lshl_b32 s88, s88, 16
    s_lshl_b32 s89, s94, 9
    s_add_u32 s88, s88, s89
    s_and_b32 s89, s28, 1
    s_lshl_b32 s89, s89, 8
    s_add_u32 s88, s88, s89
    s_add_u32 s38, s38, s88
    s_addc_u32 s39, s39, 0
    s_add_u32 s40, s26, 262144
    s_addc_u32 s41, s27, 0
    s_lshl_b32 s88, s95, 15
    s_add_u32 s50, s50, s88
    s_add_u32 s42, s26, 2097152
    s_addc_u32 s43, s27, 0
    s_add_u32 s42, s42, s50
    s_addc_u32 s43, s43, 0
    s_lshr_b32 s88, s30, 2
    s_and_b32 s88, s88, 1
    s_lshl_b32 s50, s88, 14
    s_and_b32 s89, s30, 3
    s_lshl_b32 s89, s89, 12
    s_add_u32 s50, s50, s89
    s_add_u32 s44, s42, s50
    s_addc_u32 s45, s43, 0
    s_mul_i32 s50, s88, 112
    s_add_u32 s50, s50, s33
    s_lshl_b32 s50, s50, 11
    s_add_u32 s46, s26, 524288
    s_addc_u32 s47, s27, 0
    s_add_u32 s46, s46, s50
    s_addc_u32 s47, s47, 0
    s_lshl_b32 s88, s34, 4
    s_lshl_b32 s50, s31, 16
    s_add_u32 s50, s50, s88
    s_add_u32 s48, s26, 262144
    s_addc_u32 s49, s27, 0
    s_add_u32 s48, s48, s50
    s_addc_u32 s49, s49, 0
    s_mul_i32 s50, s31, 229376
    s_add_u32 s50, s50, s88
    s_add_u32 s86, s26, 524288
    s_addc_u32 s87, s27, 0
    s_add_u32 s86, s86, s50
    s_addc_u32 s87, s87, 0
    s_lshl_b32 s50, s31, 10
    s_lshl_b32 s88, s34, 3
    s_add_u32 s50, s50, s88
    s_add_u32 s90, s22, 0
    s_addc_u32 s91, s23, 0
    s_add_u32 s90, s90, s50
    s_addc_u32 s91, s91, 0
    s_lshl_b32 s88, s93, 2
    s_add_u32 s88, s88, s28
    s_mul_i32 s88, s88, 57344
    s_lshl_b32 s52, s92, 7
    s_add_u32 s52, s52, s88
    s_lshl_b32 s3, s33, 14
    s_lshl_b32 s88, s28, 8
    s_add_u32 s3, s3, s88
    s_waitcnt vmcnt(4)
    ds_read_b64_tr_b16 v[48:49], v8 offset:8192
    ds_read_b64_tr_b16 v[50:51], v8 offset:12288
    ds_read_b64_tr_b16 v[52:53], v9 offset:8192
    ds_read_b64_tr_b16 v[54:55], v9 offset:12288
    ds_read_b64_tr_b16 v[56:57], v10 offset:8192
    ds_read_b64_tr_b16 v[58:59], v10 offset:12288
    ds_read_b64_tr_b16 v[60:61], v11 offset:8192
    ds_read_b64_tr_b16 v[62:63], v11 offset:12288
    ds_read_b64_tr_b16 v[64:65], v12 offset:8192
    ds_read_b64_tr_b16 v[66:67], v12 offset:12288
    ds_read_b64_tr_b16 v[68:69], v13 offset:8192
    ds_read_b64_tr_b16 v[70:71], v13 offset:12288
    ds_read_b64_tr_b16 v[72:73], v14 offset:8192
    ds_read_b64_tr_b16 v[74:75], v14 offset:12288
    s_waitcnt lgkmcnt(6)
    v_mfma_f32_16x16x32_bf16 v[144:147], v[48:51], v[32:35], v[144:147]
    ds_read_b64_tr_b16 v[76:77], v15 offset:8192
    ds_read_b64_tr_b16 v[78:79], v15 offset:12288
    v_mfma_f32_16x16x32_bf16 v[144:147], v[52:55], v[36:39], v[144:147]
    v_mfma_f32_16x16x32_bf16 v[144:147], v[56:59], v[40:43], v[144:147]
    v_mfma_f32_16x16x32_bf16 v[144:147], v[60:63], v[44:47], v[144:147]
    s_waitcnt lgkmcnt(0)
    v_mfma_f32_16x16x32_bf16 v[148:151], v[64:67], v[32:35], v[148:151]
    v_mfma_f32_16x16x32_bf16 v[148:151], v[68:71], v[36:39], v[148:151]
    v_mfma_f32_16x16x32_bf16 v[148:151], v[72:75], v[40:43], v[148:151]
    v_mfma_f32_16x16x32_bf16 v[148:151], v[76:79], v[44:47], v[148:151]
    v_mfma_f32_16x16x32_bf16 v[176:179], v[204:207], v[184:187], v[176:179]
    s_nop 6
    ds_write_b128 v219, v[144:147]
    ds_write_b128 v219, v[148:151] offset:256
    ds_write_b32 v220, v176
    s_waitcnt lgkmcnt(0)
    s_cbranch_execz Lz_8
    s_barrier
Lz_8:
    ds_read_b64 v[48:49], v221 offset:0
    ds_read_b64 v[50:51], v221 offset:2112
    ds_read_b64 v[52:53], v221 offset:4224
    ds_read_b64 v[54:55], v221 offset:6336
    ds_read_b128 v[56:59], v254
    v_mov_b32 v64, v197
    v_mov_b32 v66, v197
    s_waitcnt lgkmcnt(1)
    v_mul_f32 v60, v208, v48
    v_mul_f32 v61, v208, v49
    v_fmac_f32 v60, v209, v50
    v_fmac_f32 v61, v209, v51
    v_fmac_f32 v60, v210, v52
    v_fmac_f32 v61, v210, v53
    v_fmac_f32 v60, v211, v54
    v_fmac_f32 v61, v211, v55
    v_bfi_b32 v60, s54, v60, v214
    v_bfi_b32 v61, s54, v61, v214
    s_cbranch_execz Lz_9
    s_cmp_eq_u32 s24, 0
    s_cbranch_scc1 Ls_10
    global_store_dwordx2 v223, v[60:61], s[36:37]
    s_branch Lz_9
Ls_10:
    global_store_dwordx2 v223, v[60:61], s[36:37] sc1
Lz_9:
    s_waitcnt lgkmcnt(0)
    v_mul_f32 v62, v208, v56
    v_fmac_f32 v62, v209, v57
    v_fmac_f32 v62, v210, v58
    v_fmac_f32 v62, v211, v59
    v_bfi_b32 v65, s54, v62, v214
    s_mov_b64 exec, s[78:79]
    v_mov_b32 v67, v65
    s_cbranch_execz Lz_11
    s_cmp_eq_u32 s24, 0
    s_cbranch_scc1 Ls_12
    global_store_dwordx4 v224, v[64:67], s[36:37]
    s_branch Lz_11
Ls_12:
    global_store_dwordx4 v224, v[64:67], s[36:37] sc1
Lz_11:
    s_mov_b64 exec, s[56:57]
    s_sleep 3
    s_cbranch_execz Lz_16
    global_load_dwordx4 v[48:51], v225, s[38:39]  sc1
    global_load_dwordx4 v[52:55], v226, s[38:39]  sc1
    global_load_dwordx4 v[56:59], v227, s[38:39]  sc1
    global_load_dwordx4 v[60:63], v228, s[38:39]  sc1
    global_load_dwordx4 v[64:67], v229, s[38:39]  sc1
Lz_16:
Lc_15:
    s_waitcnt vmcnt(0)
    v_msad_u8 v68, v48, s53, 0
    v_msad_u8 v68, v49, s53, v68
    v_msad_u8 v68, v50, s53, v68
    v_msad_u8 v68, v51, s53, v68
    v_msad_u8 v68, v52, s53, v68
    v_msad_u8 v68, v53, s53, v68
    v_msad_u8 v68, v54, s53, v68
    v_msad_u8 v68, v55, s53, v68
    v_msad_u8 v68, v56, s53, v68
    v_msad_u8 v68, v57, s53, v68
    v_msad_u8 v68, v58, s53, v68
    v_msad_u8 v68, v59, s53, v68
    v_msad_u8 v68, v60, s53, v68
    v_msad_u8 v68, v61, s53, v68
    v_msad_u8 v68, v62, s53, v68
    v_msad_u8 v68, v63, s53, v68
    v_msad_u8 v68, v64, s53, v68
    v_msad_u8 v68, v65, s53, v68
    v_msad_u8 v68, v66, s53, v68
    v_msad_u8 v68, v67, s53, v68
    v_cmp_ne_u32 vcc, 0, v68
    s_cbranch_execz Lf_17
    s_cbranch_vccz Lok_14
Lf_17:
    v_msad_u8 v68, v48, s53, 0
    v_msad_u8 v68, v49, s53, v68
    v_msad_u8 v68, v50, s53, v68
    v_msad_u8 v68, v51, s53, v68
    v_cmp_ne_u32 s[12:13], 0, v68
    v_msad_u8 v68, v52, s53, 0
    v_msad_u8 v68, v53, s53, v68
    v_msad_u8 v68, v54, s53, v68
    v_msad_u8 v68, v55, s53, v68
    v_cmp_ne_u32 s[16:17], 0, v68
    v_msad_u8 v68, v56, s53, 0
    v_msad_u8 v68, v57, s53, v68
    v_msad_u8 v68, v58, s53, v68
    v_msad_u8 v68, v59, s53, v68
    v_cmp_ne_u32 s[18:19], 0, v68
    v_msad_u8 v68, v60, s53, 0
    v_msad_u8 v68, v61, s53, v68
    v_msad_u8 v68, v62, s53, v68
    v_msad_u8 v68, v63, s53, v68
    v_cmp_ne_u32 s[20:21], 0, v68
    v_msad_u8 v68, v64, s53, 0
    v_msad_u8 v68, v65, s53, v68
    v_msad_u8 v68, v66, s53, v68
    v_msad_u8 v68, v67, s53, v68
    v_cmp_ne_u32 s[4:5], 0, v68
    s_sub_u32 s55, s55, 1
    s_cbranch_scc1 L_END
    s_mov_b64 exec, s[12:13]
    s_cbranch_execz Lz_18
    global_load_dwordx4 v[48:51], v225, s[38:39]  sc1
Lz_18:
    s_mov_b64 exec, s[16:17]
    s_cbranch_execz Lz_19
    global_load_dwordx4 v[52:55], v226, s[38:39]  sc1
Lz_19:
    s_mov_b64 exec, s[18:19]
    s_cbranch_execz Lz_20
    global_load_dwordx4 v[56:59], v227, s[38:39]  sc1
Lz_20:
    s_mov_b64 exec, s[20:21]
    s_cbranch_execz Lz_21
    global_load_dwordx4 v[60:63], v228, s[38:39]  sc1
Lz_21:
    s_mov_b64 exec, s[4:5]
    s_cbranch_execz Lz_22
    global_load_dwordx4 v[64:67], v229, s[38:39]  sc1
Lz_22:
    s_mov_b64 exec, s[56:57]
    s_cbranch_execnz Lc_15
Lok_14:
    v_and_b32 v64, s54, v64
    v_and_b32 v65, s54, v65
    v_and_b32 v48, s54, v48
    v_max_f32_dpp v68, v64, v64 quad_perm:[1,0,3,2] row_mask:0xf bank_mask:0xf
    v_and_b32 v49, s54, v49
    v_and_b32 v50, s54, v50
    v_max_f32_dpp v68, v68, v68 quad_perm:[2,3,0,1] row_mask:0xf bank_mask:0xf
    v_mov_b32 v69, v68
    v_and_b32 v51, s54, v51
    v_and_b32 v52, s54, v52
    v_permlane16_swap_b32 v68, v69
    v_max_f32 v68, v68, v69
    v_mov_b32 v69, v68
    v_and_b32 v53, s54, v53
    v_and_b32 v54, s54, v54
    v_permlane32_swap_b32 v68, v69
    v_max_f32 v68, v68, v69
    v_sub_f32 v64, v64, v68
    v_exp_f32 v64, v64
    v_and_b32 v55, s54, v55
    v_mul_f32 v65, v64, v65
    v_and_b32 v56, s54, v56
    v_and_b32 v57, s54, v57
    v_and_b32 v58, s54, v58
    v_and_b32 v59, s54, v59
    v_and_b32 v60, s54, v60
    v_and_b32 v61, s54, v61
    v_and_b32 v62, s54, v62
    v_and_b32 v63, s54, v63
    v_mul_f32_dpp v48, v64, v48 row_newbcast:0 row_mask:0xf bank_mask:0xf
    v_mul_f32_dpp v49, v64, v49 row_newbcast:0 row_mask:0xf bank_mask:0xf
    v_mul_f32_dpp v50, v64, v50 row_newbcast:0 row_mask:0xf bank_mask:0xf
    v_mul_f32_dpp v51, v64, v51 row_newbcast:0 row_mask:0xf bank_mask:0xf
    v_add_f32_dpp v65, v65, v65 quad_perm:[1,0,3,2] row_mask:0xf bank_mask:0xf
    v_fmac_f32_dpp v48, v64, v52 row_newbcast:1 row_mask:0xf bank_mask:0xf
    v_fmac_f32_dpp v49, v64, v53 row_newbcast:1 row_mask:0xf bank_mask:0xf
    v_fmac_f32_dpp v50, v64, v54 row_newbcast:1 row_mask:0xf bank_mask:0xf
    v_fmac_f32_dpp v51, v64, v55 row_newbcast:1 row_mask:0xf bank_mask:0xf
    v_add_f32_dpp v65, v65, v65 quad_perm:[2,3,0,1] row_mask:0xf bank_mask:0xf
    v_fmac_f32_dpp v48, v64, v56 row_newbcast:2 row_mask:0xf bank_mask:0xf
    v_fmac_f32_dpp v49, v64, v57 row_newbcast:2 row_mask:0xf bank_mask:0xf
    v_fmac_f32_dpp v50, v64, v58 row_newbcast:2 row_mask:0xf bank_mask:0xf
    v_fmac_f32_dpp v51, v64, v59 row_newbcast:2 row_mask:0xf bank_mask:0xf
    v_mov_b32 v66, v65
    v_fmac_f32_dpp v48, v64, v60 row_newbcast:3 row_mask:0xf bank_mask:0xf
    v_fmac_f32_dpp v49, v64, v61 row_newbcast:3 row_mask:0xf bank_mask:0xf
    v_fmac_f32_dpp v50, v64, v62 row_newbcast:3 row_mask:0xf bank_mask:0xf
    v_fmac_f32_dpp v51, v64, v63 row_newbcast:3 row_mask:0xf bank_mask:0xf
    v_permlane16_swap_b32 v65, v66
    v_add_f32 v65, v65, v66
    v_mov_b32 v66, v65
    v_permlane16_swap_b32 v48, v49
    v_permlane16_swap_b32 v50, v51
    v_permlane32_swap_b32 v65, v66
    v_add_f32 v48, v48, v49
    v_add_f32 v50, v50, v51
    v_add_f32 v65, v65, v66
    v_rcp_f32 v65, v65
    v_permlane32_swap_b32 v48, v50
    v_add_f32 v48, v48, v50
    v_mul_f32 v48, v48, v65
    v_cvt_pk_bf16_f32 v48, v48, v48
    ds_write_b16 v230, v48
    s_waitcnt lgkmcnt(0)
    s_cbranch_execz Lz_23
    s_barrier
Lz_23:
    ds_read_b128 v[48:51], v231 offset:0
    ds_read_b64_tr_b16 v[80:81], v232 offset:0
    ds_read_b64_tr_b16 v[82:83], v232 offset:512
    ds_read_b128 v[52:55], v231 offset:64
    ds_read_b64_tr_b16 v[84:85], v232 offset:32768
    ds_read_b64_tr_b16 v[86:87], v232 offset:33280
    ds_read_b128 v[56:59], v231 offset:128
    ds_read_b64_tr_b16 v[88:89], v233 offset:0
    ds_read_b64_tr_b16 v[90:91], v233 offset:512
    ds_read_b128 v[60:63], v231 offset:192
    ds_read_b64_tr_b16 v[92:93], v233 offset:32768
    ds_read_b64_tr_b16 v[94:95], v233 offset:33280
    s_cbranch_execz Lz_24
    s_add_u32 m0, s51, 28672
    s_add_u32 s50, s52, 0
    buffer_load_dwordx4 v217, s[64:67], s50 offen nt lds
    s_add_u32 m0, s51, 29696
    s_add_u32 s50, s52, 28672
    buffer_load_dwordx4 v217, s[64:67], s50 offen nt lds
    s_add_u32 m0, s51, 30720
    s_add_u32 s50, s52, 0
    buffer_load_dwordx4 v217, s[68:71], s50 offen nt lds
    s_add_u32 m0, s51, 31744
    s_add_u32 s50, s52, 28672
    buffer_load_dwordx4 v217, s[68:71], s50 offen nt lds
Lz_24:
    s_waitcnt lgkmcnt(9)
    v_mfma_f32_16x16x32_bf16 v[64:67], v[48:51], v[80:83], 0
    s_waitcnt lgkmcnt(6)
    v_mfma_f32_16x16x32_bf16 v[64:67], v[52:55], v[84:87], v[64:67]
    s_waitcnt lgkmcnt(3)
    v_mfma_f32_16x16x32_bf16 v[64:67], v[56:59], v[88:91], v[64:67]
    s_waitcnt lgkmcnt(0)
    v_mfma_f32_16x16x32_bf16 v[64:67], v[60:63], v[92:95], v[64:67]
    s_nop 6
    s_mov_b64 exec, s[76:77]
    v_cndmask_b32 v68, v64, v65, s[84:85]
    v_bfi_b32 v68, s54, v68, v214
    s_cbranch_execz Lz_25
    global_store_dword v234, v68, s[40:41] sc1
Lz_25:
    s_mov_b64 exec, s[56:57]
    s_cbranch_execz Lz_26
    s_add_u32 m0, s51, 0
    s_add_u32 s50, s3, 0
    buffer_load_dwordx4 v218, s[72:75], s50 offen nt lds
    s_add_u32 m0, s51, 1024
    s_add_u32 s50, s3, 4096
    buffer_load_dwordx4 v218, s[72:75], s50 offen nt lds
    s_add_u32 m0, s51, 2048
    s_add_u32 s50, s3, 8192
    buffer_load_dwordx4 v218, s[72:75], s50 offen nt lds
    s_add_u32 m0, s51, 3072
    s_add_u32 s50, s3, 12288
    buffer_load_dwordx4 v218, s[72:75], s50 offen nt lds
Lz_26:
    s_sleep 14
    s_cbranch_execz Lz_30
    global_load_dwordx4 v[48:51], v235, s[40:41]  sc1
    global_load_dwordx4 v[52:55], v236, s[40:41]  sc1
    global_load_dwordx4 v[56:59], v237, s[40:41]  sc1
    global_load_dwordx4 v[60:63], v238, s[40:41]  sc1
Lz_30:
Lc_29:
    s_waitcnt vmcnt(0)
    v_msad_u8 v64, v48, s53, 0
    v_msad_u8 v64, v49, s53, v64
    v_msad_u8 v64, v50, s53, v64
    v_msad_u8 v64, v51, s53, v64
    v_msad_u8 v64, v52, s53, v64
    v_msad_u8 v64, v53, s53, v64
    v_msad_u8 v64, v54, s53, v64
    v_msad_u8 v64, v55, s53, v64
    v_msad_u8 v64, v56, s53, v64
    v_msad_u8 v64, v57, s53, v64
    v_msad_u8 v64, v58, s53, v64
    v_msad_u8 v64, v59, s53, v64
    v_msad_u8 v64, v60, s53, v64
    v_msad_u8 v64, v61, s53, v64
    v_msad_u8 v64, v62, s53, v64
    v_msad_u8 v64, v63, s53, v64
    v_cmp_ne_u32 vcc, 0, v64
    s_cbranch_execz Lf_31
    s_cbranch_vccz Lok_28
Lf_31:
    v_msad_u8 v64, v48, s53, 0
    v_msad_u8 v64, v49, s53, v64
    v_msad_u8 v64, v50, s53, v64
    v_msad_u8 v64, v51, s53, v64
    v_cmp_ne_u32 s[12:13], 0, v64
    v_msad_u8 v64, v52, s53, 0
    v_msad_u8 v64, v53, s53, v64
    v_msad_u8 v64, v54, s53, v64
    v_msad_u8 v64, v55, s53, v64
    v_cmp_ne_u32 s[16:17], 0, v64
    v_msad_u8 v64, v56, s53, 0
    v_msad_u8 v64, v57, s53, v64
    v_msad_u8 v64, v58, s53, v64
    v_msad_u8 v64, v59, s53, v64
    v_cmp_ne_u32 s[18:19], 0, v64
    v_msad_u8 v64, v60, s53, 0
    v_msad_u8 v64, v61, s53, v64
    v_msad_u8 v64, v62, s53, v64
    v_msad_u8 v64, v63, s53, v64
    v_cmp_ne_u32 s[20:21], 0, v64
    s_sub_u32 s55, s55, 1
    s_cbranch_scc1 L_END
    s_mov_b64 exec, s[12:13]
    s_cbranch_execz Lz_32
    global_load_dwordx4 v[48:51], v235, s[40:41]  sc1
Lz_32:
    s_mov_b64 exec, s[16:17]
    s_cbranch_execz Lz_33
    global_load_dwordx4 v[52:55], v236, s[40:41]  sc1
Lz_33:
    s_mov_b64 exec, s[18:19]
    s_cbranch_execz Lz_34
    global_load_dwordx4 v[56:59], v237, s[40:41]  sc1
Lz_34:
    s_mov_b64 exec, s[20:21]
    s_cbranch_execz Lz_35
    global_load_dwordx4 v[60:63], v238, s[40:41]  sc1
Lz_35:
    s_mov_b64 exec, s[56:57]
    s_cbranch_execnz Lc_29
Lok_28:
    v_and_b32 v48, s54, v48
    v_and_b32 v49, s54, v49
    v_and_b32 v50, s54, v50
    v_and_b32 v51, s54, v51
    v_and_b32 v52, s54, v52
    v_and_b32 v53, s54, v53
    v_and_b32 v54, s54, v54
    v_and_b32 v55, s54, v55
    v_add_f32 v48, v48, v52
    v_add_f32 v49, v49, v53
    v_add_f32 v50, v50, v54
    v_add_f32 v51, v51, v55
    v_and_b32 v56, s54, v56
    v_and_b32 v57, s54, v57
    v_and_b32 v58, s54, v58
    v_and_b32 v59, s54, v59
    v_permlane16_swap_b32 v48, v49
    v_permlane16_swap_b32 v50, v51
    v_and_b32 v60, s54, v60
    v_and_b32 v61, s54, v61
    v_and_b32 v62, s54, v62
    v_and_b32 v63, s54, v63
    v_add_f32 v48, v48, v49
    v_add_f32 v50, v50, v51
    v_add_f32 v56, v56, v60
    v_add_f32 v57, v57, v61
    v_add_f32 v58, v58, v62
    v_add_f32 v59, v59, v63
    v_permlane32_swap_b32 v48, v50
    v_add_f32 v48, v48, v50
    v_permlane16_swap_b32 v56, v57
    v_permlane16_swap_b32 v58, v59
    ds_write_b32 v239, v48
    v_add_f32 v56, v56, v57
    v_add_f32 v58, v58, v59
    s_nop 1
    v_permlane32_swap_b32 v56, v58
    v_add_f32 v56, v56, v58
    ds_write_b32 v239, v56 offset:256
    s_waitcnt lgkmcnt(0)
    s_cbranch_execz Lz_36
    s_barrier
Lz_36:
    ds_read_b64 v[48:49], v240 offset:0
    ds_read_b64 v[50:51], v240 offset:512
    ds_read_b64 v[52:53], v240 offset:1024
    ds_read_b64 v[54:55], v240 offset:1536
    ds_read_b64_tr_b16 v[96:97], v243 offset:0
    ds_read_b64_tr_b16 v[98:99], v243 offset:512
    ds_read_b64_tr_b16 v[100:101], v244 offset:0
    ds_read_b64_tr_b16 v[102:103], v244 offset:512
    ds_read_b64_tr_b16 v[104:105], v243 offset:2048
    ds_read_b64_tr_b16 v[106:107], v243 offset:2560
    ds_read_b64_tr_b16 v[108:109], v244 offset:2048
    ds_read_b64_tr_b16 v[110:111], v244 offset:2560
    v_lshlrev_b32 v56, 16, v212
    v_and_b32 v57, 0xffff0000, v212
    s_waitcnt lgkmcnt(8)
    v_add_f32 v48, v48, v50
    v_add_f32 v49, v49, v51
    v_add_f32 v52, v52, v54
    v_add_f32 v53, v53, v55
    v_add_f32 v48, v48, v52
    v_add_f32 v49, v49, v53
    v_cvt_pk_bf16_f32 v50, v48, v49
    v_lshlrev_b32 v48, 16, v50
    v_and_b32 v49, 0xffff0000, v50
    v_add_f32 v48, v48, v56
    v_add_f32 v49, v49, v57
    v_cvt_pk_bf16_f32 v50, v48, v49
    ds_write_b32 v241, v50
    v_lshlrev_b32 v48, 16, v50
    v_and_b32 v49, 0xffff0000, v50
    v_add_f32 v52, v48, v49
    v_mul_f32 v53, v48, v48
    v_fmac_f32 v53, v49, v49
    s_waitcnt lgkmcnt(0)
    ds_read_b128 v[64:67], v242 offset:0
    ds_read_b128 v[68:71], v242 offset:64
    v_add_f32_dpp v52, v52, v52 row_ror:8 row_mask:0xf bank_mask:0xf
    v_add_f32_dpp v53, v53, v53 row_ror:8 row_mask:0xf bank_mask:0xf
    s_nop 0
    v_add_f32_dpp v52, v52, v52 row_ror:4 row_mask:0xf bank_mask:0xf
    v_add_f32_dpp v53, v53, v53 row_ror:4 row_mask:0xf bank_mask:0xf
    s_nop 0
    v_add_f32_dpp v52, v52, v52 row_ror:2 row_mask:0xf bank_mask:0xf
    v_add_f32_dpp v53, v53, v53 row_ror:2 row_mask:0xf bank_mask:0xf
    s_nop 0
    v_add_f32_dpp v52, v52, v52 row_ror:1 row_mask:0xf bank_mask:0xf
    v_add_f32_dpp v53, v53, v53 row_ror:1 row_mask:0xf bank_mask:0xf
    s_waitcnt lgkmcnt(0)
    v_mfma_f32_16x16x32_bf16 v[72:75], v[64:67], v[96:99], 0
    v_mfma_f32_16x16x32_bf16 v[76:79], v[64:67], v[104:107], 0
    v_mfma_f32_16x16x32_bf16 v[72:75], v[68:71], v[100:103], v[72:75]
    v_mfma_f32_16x16x32_bf16 v[76:79], v[68:71], v[108:111], v[76:79]
    v_permlane16_swap_b32 v52, v53
    v_add_f32 v52, v52, v53
    v_mov_b32 v53, v52
    s_nop 1
    v_permlane16_swap_b32 v52, v53
    v_bfi_b32 v56, s54, v52, v214
    v_bfi_b32 v57, s54, v53, v214
    v_mov_b32 v58, v56
    v_mov_b32 v59, v57
    s_mov_b64 exec, s[6:7]
    v_cndmask_b32 v60, v72, v73, s[84:85]
    v_cndmask_b32 v62, v76, v77, s[84:85]
    v_bfi_b32 v60, s54, v60, v214
    v_bfi_b32 v61, s54, v74, v214
    v_bfi_b32 v62, s54, v62, v214
    v_bfi_b32 v63, s54, v78, v214
    s_cbranch_execz Lz_37
    s_cmp_eq_u32 s24, 0
    s_cbranch_scc1 Ls_38
    global_store_dwordx4 v246, v[60:63], s[42:43]
    s_branch Lz_37
Ls_38:
    global_store_dwordx4 v246, v[60:63], s[42:43] sc1
Lz_37:
    s_mov_b64 exec, s[8:9]
    s_cbranch_execz Lz_39
    s_cmp_eq_u32 s24, 0
    s_cbranch_scc1 Ls_40
    global_store_dwordx4 v247, v[56:59], s[42:43]
    s_branch Lz_39
Ls_40:
    global_store_dwordx4 v247, v[56:59], s[42:43] sc1
Lz_39:
    s_mov_b64 exec, s[56:57]
    s_sleep 3
    s_cbranch_execz Lz_44
    global_load_dwordx4 v[48:51], v248, s[44:45]  sc1
    global_load_dwordx4 v[52:55], v248, s[44:45] offset:2048 sc1
    global_load_dwordx4 v[56:59], v249, s[44:45]  sc1
Lz_44:
Lc_43:
    s_waitcnt vmcnt(0)
    v_msad_u8 v64, v48, s53, 0
    v_msad_u8 v64, v49, s53, v64
    v_msad_u8 v64, v50, s53, v64
    v_msad_u8 v64, v51, s53, v64
    v_msad_u8 v64, v52, s53, v64
    v_msad_u8 v64, v53, s53, v64
    v_msad_u8 v64, v54, s53, v64
    v_msad_u8 v64, v55, s53, v64
    v_msad_u8 v64, v56, s53, v64
    v_msad_u8 v64, v57, s53, v64
    v_msad_u8 v64, v58, s53, v64
    v_msad_u8 v64, v59, s53, v64
    v_cmp_ne_u32 vcc, 0, v64
    s_cbranch_execz Lf_45
    s_cbranch_vccz Lok_42
Lf_45:
    v_msad_u8 v64, v48, s53, 0
    v_msad_u8 v64, v49, s53, v64
    v_msad_u8 v64, v50, s53, v64
    v_msad_u8 v64, v51, s53, v64
    v_cmp_ne_u32 s[12:13], 0, v64
    v_msad_u8 v64, v52, s53, 0
    v_msad_u8 v64, v53, s53, v64
    v_msad_u8 v64, v54, s53, v64
    v_msad_u8 v64, v55, s53, v64
    v_cmp_ne_u32 s[16:17], 0, v64
    v_msad_u8 v64, v56, s53, 0
    v_msad_u8 v64, v57, s53, v64
    v_msad_u8 v64, v58, s53, v64
    v_msad_u8 v64, v59, s53, v64
    v_cmp_ne_u32 s[18:19], 0, v64
    s_sub_u32 s55, s55, 1
    s_cbranch_scc1 L_END
    s_mov_b64 exec, s[12:13]
    s_cbranch_execz Lz_46
    global_load_dwordx4 v[48:51], v248, s[44:45]  sc1
Lz_46:
    s_mov_b64 exec, s[16:17]
    s_cbranch_execz Lz_47
    global_load_dwordx4 v[52:55], v248, s[44:45] offset:2048 sc1
Lz_47:
    s_mov_b64 exec, s[18:19]
    s_cbranch_execz Lz_48
    global_load_dwordx4 v[56:59], v249, s[44:45]  sc1
Lz_48:
    s_mov_b64 exec, s[56:57]
    s_cbranch_execnz Lc_43
Lok_42:
    ds_read_b64_tr_b16 v[80:81], v245 offset:0
    ds_read_b64_tr_b16 v[82:83], v245 offset:8
    ds_read_b64_tr_b16 v[84:85], v245 offset:16
    ds_read_b64_tr_b16 v[86:87], v245 offset:24
    ds_read_b64_tr_b16 v[88:89], v245 offset:32
    ds_read_b64_tr_b16 v[90:91], v245 offset:40
    ds_read_b64_tr_b16 v[92:93], v245 offset:48
    ds_read_b64_tr_b16 v[94:95], v245 offset:56
    v_and_b32 v56, s54, v56
    v_and_b32 v57, s54, v57
    v_and_b32 v48, s54, v48
    v_and_b32 v49, s54, v49
    v_and_b32 v50, s54, v50
    v_and_b32 v51, s54, v51
    v_add_f32_dpp v56, v56, v56 row_ror:1 row_mask:0xf bank_mask:0xf
    v_add_f32_dpp v57, v57, v57 row_ror:1 row_mask:0xf bank_mask:0xf
    v_and_b32 v52, s54, v52
    v_and_b32 v53, s54, v53
    v_add_f32_dpp v56, v56, v56 row_ror:2 row_mask:0xf bank_mask:0xf
    v_add_f32_dpp v57, v57, v57 row_ror:2 row_mask:0xf bank_mask:0xf
    v_and_b32 v54, s54, v54
    v_and_b32 v55, s54, v55
    v_add_f32_dpp v56, v56, v56 row_ror:4 row_mask:0xf bank_mask:0xf
    v_add_f32_dpp v57, v57, v57 row_ror:4 row_mask:0xf bank_mask:0xf
    v_add_f32 v48, v48, v52
    v_add_f32 v49, v49, v53
    v_add_f32 v50, v50, v54
    v_add_f32 v51, v51, v55
    v_mul_f32 v56, 0x3b000000, v56
    v_mul_f32 v57, 0x3b000000, v57
    v_permlane16_swap_b32 v48, v49
    v_permlane16_swap_b32 v50, v51
    v_fma_f32 v57, -v56, v56, v57
    v_add_f32 v48, v48, v49
    v_add_f32 v50, v50, v51
    v_max_f32 v57, 0, v57
    v_add_f32 v57, 0x3727c5ac, v57
    v_permlane32_swap_b32 v48, v50
    v_rsq_f32 v57, v57
    v_add_f32 v48, v48, v50
    v_mul_f32 v49, v56, v48
    v_cndmask_b32 v48, v48, -v49, s[84:85]
    v_mov_b32 v49, v48
    s_mov_b32 s88, 0x00010001
    s_mov_b32 s89, 0x00010001
    v_permlane16_swap_b32 v48, v49
    v_add_f32 v48, v48, v49
    v_mul_f32 v48, v48, v57
    v_mov_b32 v49, v48
    s_nop 1
    v_permlane32_swap_b32 v48, v49
    v_mul_f32 v50, 0xbfb8aa3b, v48
    v_exp_f32 v50, v50
    v_mul_f32 v48, v48, v49
    v_add_f32 v50, 1.0, v50
    v_rcp_f32 v50, v50
    s_nop 0
    v_mul_f32 v48, v48, v50
    v_mov_b32 v49, v48
    s_nop 0
    v_mov_b32_dpp v49, v48 row_ror:12 row_mask:0x2 bank_mask:0xf
    v_mov_b32_dpp v49, v48 row_ror:8 row_mask:0x4 bank_mask:0xf
    v_mov_b32_dpp v49, v48 row_ror:4 row_mask:0x8 bank_mask:0xf
    s_nop 1
    v_mov_b32_dpp v52, v49 row_newbcast:0 row_mask:0xf bank_mask:0xf
    v_mov_b32_dpp v53, v49 row_newbcast:1 row_mask:0xf bank_mask:0xf
    v_mov_b32_dpp v54, v49 row_newbcast:2 row_mask:0xf bank_mask:0xf
    v_mov_b32_dpp v55, v49 row_newbcast:3 row_mask:0xf bank_mask:0xf
    v_cvt_pk_bf16_f32 v50, v52, v53
    v_cvt_pk_bf16_f32 v51, v54, v55
    s_waitcnt lgkmcnt(0)
    v_cndmask_b32 v56, 0, v50, s[88:89]
    v_cndmask_b32 v57, 0, v51, s[88:89]
    s_lshl_b64 s[88:89], s[88:89], 1
    v_cndmask_b32 v58, 0, v50, s[88:89]
    v_cndmask_b32 v59, 0, v51, s[88:89]
    s_lshl_b64 s[88:89], s[88:89], 1
    v_cndmask_b32 v60, 0, v50, s[88:89]
    v_cndmask_b32 v61, 0, v51, s[88:89]
    s_lshl_b64 s[88:89], s[88:89], 1
    v_mfma_f32_16x16x16_bf16 v[72:75], v[80:81], v[56:57], 0
    v_cndmask_b32 v62, 0, v50, s[88:89]
    v_cndmask_b32 v63, 0, v51, s[88:89]
    s_lshl_b64 s[88:89], s[88:89], 1
    v_mfma_f32_16x16x16_bf16 v[72:75], v[82:83], v[58:59], v[72:75]
    v_cndmask_b32 v64, 0, v50, s[88:89]
    v_cndmask_b32 v65, 0, v51, s[88:89]
    s_lshl_b64 s[88:89], s[88:89], 1
    v_mfma_f32_16x16x16_bf16 v[72:75], v[84:85], v[60:61], v[72:75]
    v_cndmask_b32 v66, 0, v50, s[88:89]
    v_cndmask_b32 v67, 0, v51, s[88:89]
    s_lshl_b64 s[88:89], s[88:89], 1
    v_mfma_f32_16x16x16_bf16 v[72:75], v[86:87], v[62:63], v[72:75]
    v_cndmask_b32 v68, 0, v50, s[88:89]
    v_cndmask_b32 v69, 0, v51, s[88:89]
    s_lshl_b64 s[88:89], s[88:89], 1
    v_mfma_f32_16x16x16_bf16 v[72:75], v[88:89], v[64:65], v[72:75]
    v_cndmask_b32 v70, 0, v50, s[88:89]
    v_cndmask_b32 v71, 0, v51, s[88:89]
    v_mfma_f32_16x16x16_bf16 v[72:75], v[90:91], v[66:67], v[72:75]
    v_mfma_f32_16x16x16_bf16 v[72:75], v[92:93], v[68:69], v[72:75]
    v_mfma_f32_16x16x16_bf16 v[72:75], v[94:95], v[70:71], v[72:75]
    s_nop 6
    s_mov_b64 exec, s[10:11]
    v_bfi_b32 v72, s54, v72, v214
    v_bfi_b32 v73, s54, v73, v214
    v_bfi_b32 v74, s54, v74, v214
    v_bfi_b32 v75, s54, v75, v214
    s_cbranch_execz Lz_49
    global_store_dwordx4 v250, v[72:75], s[46:47] sc1
Lz_49:
    s_mov_b64 exec, s[56:57]
    s_cmp_lg_u32 s28, 0
    s_cbranch_scc1 L_FIN
    v_mov_b32 v48, v214
    v_mov_b32 v56, v214
    v_mov_b32 v49, v214
    v_mov_b32 v57, v214
    v_mov_b32 v50, v214
    v_mov_b32 v58, v214
    v_mov_b32 v51, v214
    v_mov_b32 v59, v214
    v_lshlrev_b32 v60, 16, v213
    s_sleep 16
    s_cbranch_execz Lz_53
    global_load_dwordx4 v[52:55], v252, s[86:87]  sc1
    s_mov_b64 exec, s[82:83]
    global_load_dwordx4 v[56:59], v255, s[86:87]  sc1
    s_mov_b64 exec, s[76:77]
    global_load_dwordx4 v[48:51], v251, s[48:49]  sc1
    s_mov_b64 exec, s[56:57]
Lz_53:
Lc_52:
    s_waitcnt vmcnt(0)
    v_msad_u8 v64, v52, s53, 0
    v_msad_u8 v64, v53, s53, v64
    v_msad_u8 v64, v54, s53, v64
    v_msad_u8 v64, v55, s53, v64
    v_msad_u8 v64, v56, s53, v64
    v_msad_u8 v64, v57, s53, v64
    v_msad_u8 v64, v58, s53, v64
    v_msad_u8 v64, v59, s53, v64
    v_msad_u8 v64, v48, s53, v64
    v_msad_u8 v64, v49, s53, v64
    v_msad_u8 v64, v50, s53, v64
    v_msad_u8 v64, v51, s53, v64
    v_cmp_ne_u32 vcc, 0, v64
    s_cbranch_execz Lf_54
    s_cbranch_vccz Lok_51
Lf_54:
    v_msad_u8 v64, v52, s53, 0
    v_msad_u8 v64, v53, s53, v64
    v_msad_u8 v64, v54, s53, v64
    v_msad_u8 v64, v55, s53, v64
    v_cmp_ne_u32 s[12:13], 0, v64
    v_msad_u8 v64, v56, s53, 0
    v_msad_u8 v64, v57, s53, v64
    v_msad_u8 v64, v58, s53, v64
    v_msad_u8 v64, v59, s53, v64
    v_cmp_ne_u32 s[16:17], 0, v64
    v_msad_u8 v64, v48, s53, 0
    v_msad_u8 v64, v49, s53, v64
    v_msad_u8 v64, v50, s53, v64
    v_msad_u8 v64, v51, s53, v64
    v_cmp_ne_u32 s[18:19], 0, v64
    s_sub_u32 s55, s55, 1
    s_cbranch_scc1 L_END
    s_mov_b64 exec, s[12:13]
    s_cbranch_execz Lz_55
    global_load_dwordx4 v[52:55], v252, s[86:87]  sc1
Lz_55:
    s_mov_b64 exec, s[16:17]
    s_cbranch_execz Lz_56
    global_load_dwordx4 v[56:59], v255, s[86:87]  sc1
Lz_56:
    s_mov_b64 exec, s[18:19]
    s_cbranch_execz Lz_57
    global_load_dwordx4 v[48:51], v251, s[48:49]  sc1
Lz_57:
    s_mov_b64 exec, s[56:57]
    s_cbranch_execnz Lc_52
Lok_51:
    v_and_b32 v48, s54, v48
    v_and_b32 v49, s54, v49
    v_and_b32 v50, s54, v50
    v_and_b32 v51, s54, v51
    v_and_b32 v52, s54, v52
    v_and_b32 v53, s54, v53
    v_permlane16_swap_b32 v48, v49
    v_permlane16_swap_b32 v50, v51
    v_and_b32 v54, s54, v54
    v_and_b32 v55, s54, v55
    v_and_b32 v56, s54, v56
    v_and_b32 v57, s54, v57
    v_and_b32 v58, s54, v58
    v_and_b32 v59, s54, v59
    v_add_f32 v48, v48, v49
    v_add_f32 v50, v50, v51
    v_add_f32 v52, v52, v56
    v_add_f32 v53, v53, v57
    v_add_f32 v54, v54, v58
    v_add_f32 v55, v55, v59
    v_permlane32_swap_b32 v48, v50
    v_add_f32 v48, v48, v50
    v_permlane16_swap_b32 v52, v53
    v_permlane16_swap_b32 v54, v55
    v_add_f32_dpp v48, v48, v48 row_ror:8 row_mask:0xf bank_mask:0xf
    v_add_f32 v52, v52, v53
    v_add_f32 v54, v54, v55
    v_add_f32_dpp v48, v48, v48 row_ror:4 row_mask:0xf bank_mask:0xf
    s_nop 0
    v_permlane32_swap_b32 v52, v54
    v_add_f32_dpp v48, v48, v48 row_ror:2 row_mask:0xf bank_mask:0xf
    v_add_f32 v52, v52, v54
    s_nop 0
    v_add_f32_dpp v48, v48, v48 row_ror:1 row_mask:0xf bank_mask:0xf
    v_add_f32_dpp v52, v52, v52 row_ror:8 row_mask:0xf bank_mask:0xf
    v_cvt_pk_bf16_f32 v48, v48, v48
    v_lshlrev_b32 v48, 16, v48
    v_add_f32_dpp v52, v52, v52 row_ror:4 row_mask:0xf bank_mask:0xf
    v_add_f32 v48, v48, v60
    v_cvt_pk_bf16_f32 v48, v48, v48
    v_add_f32_dpp v52, v52, v52 row_ror:2 row_mask:0xf bank_mask:0xf
    v_lshlrev_b32 v48, 16, v48
    s_nop 0
    v_add_f32_dpp v52, v52, v52 row_ror:1 row_mask:0xf bank_mask:0xf
    v_cvt_pk_bf16_f32 v52, v52, v52
    v_lshlrev_b32 v52, 16, v52
    v_add_f32 v52, v52, v48
    v_cvt_pk_bf16_f32 v52, v52, v52
    s_mov_b64 exec, s[60:61]
    s_cbranch_execz Lz_58
    global_store_short v253, v52, s[90:91]
    s_cmp_lg_u32 s2, 0
    s_cbranch_scc1 Lz_58
    s_mov_b64 exec, 1
    v_mov_b32 v53, 0
    global_store_dword v53, v214, s[26:27] offset:0 sc1
Lz_58:
    s_mov_b64 exec, s[56:57]
L_FIN:
L_END:
    s_endpgm
L_SERVICE_B:
    s_getreg_b32 s24, hwreg(HW_REG_XCC_ID)
    s_and_b32 s24, s24, 15
    v_add_u32 v4, 147456, v3
    v_mov_b32 v28, 0x3f803f80
    v_mov_b32 v29, v28
    v_mov_b32 v30, v28
    v_mov_b32 v31, v28
    ds_write_b128 v4, v[28:31] offset:2048
    v_mov_b32 v32, -1
    v_lshlrev_b32 v5, 2, v1
    v_add_u32 v5, 151552, v5
    v_mov_b32 v33, 0
    v_mov_b32 v7, 151688
    s_mov_b64 exec, 0xffff
    ds_write_b32 v5, v32
    s_mov_b64 exec, -1
    s_waitcnt vmcnt(1)
    ds_write_b128 v4, v[8:11]
    ds_write_b128 v4, v[12:15] offset:1024
    v_lshlrev_b32 v32, 16, v8
    v_and_b32 v33, 0xffff0000, v8
    v_lshlrev_b32 v34, 16, v9
    v_and_b32 v35, 0xffff0000, v9
    v_lshlrev_b32 v36, 16, v10
    v_and_b32 v37, 0xffff0000, v10
    v_lshlrev_b32 v38, 16, v11
    v_and_b32 v39, 0xffff0000, v11
    v_lshlrev_b32 v40, 16, v12
    v_and_b32 v41, 0xffff0000, v12
    v_lshlrev_b32 v42, 16, v13
    v_and_b32 v43, 0xffff0000, v13
    v_lshlrev_b32 v44, 16, v14
    v_and_b32 v45, 0xffff0000, v14
    v_lshlrev_b32 v46, 16, v15
    v_and_b32 v47, 0xffff0000, v15
    v_add_f32 v48, v32, v33
    v_add_f32 v48, v48, v34
    v_add_f32 v48, v48, v35
    v_add_f32 v48, v48, v36
    v_add_f32 v48, v48, v37
    v_add_f32 v48, v48, v38
    v_add_f32 v48, v48, v39
    v_add_f32 v49, v40, v41
    v_add_f32 v49, v49, v42
    v_add_f32 v49, v49, v43
    v_add_f32 v49, v49, v44
    v_add_f32 v49, v49, v45
    v_add_f32 v49, v49, v46
    v_add_f32 v49, v49, v47
    s_nop 0
    v_add_f32_dpp v48, v48, v48 row_ror:8 row_mask:0xf bank_mask:0xf
    v_add_f32_dpp v49, v49, v49 row_ror:8 row_mask:0xf bank_mask:0xf
    s_nop 0
    v_add_f32_dpp v48, v48, v48 row_ror:4 row_mask:0xf bank_mask:0xf
    v_add_f32_dpp v49, v49, v49 row_ror:4 row_mask:0xf bank_mask:0xf
    s_nop 0
    v_add_f32_dpp v48, v48, v48 row_ror:2 row_mask:0xf bank_mask:0xf
    v_add_f32_dpp v49, v49, v49 row_ror:2 row_mask:0xf bank_mask:0xf
    s_nop 0
    v_add_f32_dpp v48, v48, v48 row_ror:1 row_mask:0xf bank_mask:0xf
    v_add_f32_dpp v49, v49, v49 row_ror:1 row_mask:0xf bank_mask:0xf
    s_nop 0
    s_nop 0
    v_permlane16_swap_b32 v48, v49
    v_add_f32 v48, v48, v49
    v_mov_b32 v50, v48
    s_nop 1
    v_permlane32_swap_b32 v48, v50
    v_add_f32 v48, v48, v50
    v_mul_f32 v48, 0x3b000000, v48
    s_nop 0
    v_readlane_b32 s92, v48, 0
    v_readlane_b32 s93, v48, 16
    s_nop 1
    v_subrev_f32 v32, s92, v32
    v_subrev_f32 v33, s92, v33
    v_subrev_f32 v34, s92, v34
    v_subrev_f32 v35, s92, v35
    v_subrev_f32 v36, s92, v36
    v_subrev_f32 v37, s92, v37
    v_subrev_f32 v38, s92, v38
    v_subrev_f32 v39, s92, v39
    v_mul_f32 v48, v32, v32
    v_fmac_f32 v48, v33, v33
    v_fmac_f32 v48, v34, v34
    v_fmac_f32 v48, v35, v35
    v_fmac_f32 v48, v36, v36
    v_fmac_f32 v48, v37, v37
    v_fmac_f32 v48, v38, v38
    v_fmac_f32 v48, v39, v39
    v_subrev_f32 v40, s93, v40
    v_subrev_f32 v41, s93, v41
    v_subrev_f32 v42, s93, v42
    v_subrev_f32 v43, s93, v43
    v_subrev_f32 v44, s93, v44
    v_subrev_f32 v45, s93, v45
    v_subrev_f32 v46, s93, v46
    v_subrev_f32 v47, s93, v47
    v_mul_f32 v49, v40, v40
    v_fmac_f32 v49, v41, v41
    v_fmac_f32 v49, v42, v42
    v_fmac_f32 v49, v43, v43
    v_fmac_f32 v49, v44, v44
    v_fmac_f32 v49, v45, v45
    v_fmac_f32 v49, v46, v46
    v_fmac_f32 v49, v47, v47
    s_nop 0
    v_add_f32_dpp v48, v48, v48 row_ror:8 row_mask:0xf bank_mask:0xf
    v_add_f32_dpp v49, v49, v49 row_ror:8 row_mask:0xf bank_mask:0xf
    s_nop 0
    v_add_f32_dpp v48, v48, v48 row_ror:4 row_mask:0xf bank_mask:0xf
    v_add_f32_dpp v49, v49, v49 row_ror:4 row_mask:0xf bank_mask:0xf
    s_nop 0
    v_add_f32_dpp v48, v48, v48 row_ror:2 row_mask:0xf bank_mask:0xf
    v_add_f32_dpp v49, v49, v49 row_ror:2 row_mask:0xf bank_mask:0xf
    s_nop 0
    v_add_f32_dpp v48, v48, v48 row_ror:1 row_mask:0xf bank_mask:0xf
    v_add_f32_dpp v49, v49, v49 row_ror:1 row_mask:0xf bank_mask:0xf
    s_nop 0
    s_nop 0
    v_permlane16_swap_b32 v48, v49
    v_add_f32 v48, v48, v49
    v_mov_b32 v50, v48
    s_nop 1
    v_permlane32_swap_b32 v48, v50
    v_add_f32 v48, v48, v50
    v_mul_f32 v48, 0x3b000000, v48
    v_add_f32 v48, 0x3727c5ac, v48
    v_rsq_f32 v48, v48
    s_nop 0
    v_readlane_b32 s94, v48, 0
    v_readlane_b32 s95, v48, 16
    v_and_b32 v50, 3, v1
    v_min_u32 v50, 2, v50
    v_lshlrev_b32 v50, 10, v50
    v_lshrrev_b32 v51, 4, v1
    v_lshl_add_u32 v50, v51, 4, v50
    s_lshl_b32 s50, s90, 8
    s_add_u32 s50, s50, 147456
    v_add_u32 v50, s50, v50
    s_waitcnt lgkmcnt(0)
    ds_read_b128 v[64:67], v50 offset:0
    ds_read_b128 v[68:71], v50 offset:64
    ds_read_b128 v[72:75], v50 offset:128
    ds_read_b128 v[76:79], v50 offset:192
    v_and_b32 v52, 15, v1
    v_lshrrev_b32 v52, 2, v52
    v_lshl_add_u32 v52, v51, 3, v52
    v_lshlrev_b32 v52, 7, v52
    v_and_b32 v53, 3, v1
    v_lshl_add_u32 v52, v53, 3, v52
    v_add_u32 v52, 131072, v52
    s_mov_b32 s84, 0xffff0000
    s_mov_b32 s85, 0xffff0000
    s_mov_b32 s14, 0
    s_mov_b32 s15, -1
    s_add_u32 s88, s26, 131072
    s_addc_u32 s89, s27, 0
    s_lshl_b32 s50, s29, 13
    s_lshl_b32 s86, s90, 11
    s_add_u32 s50, s50, s86
    s_lshl_b32 s86, s91, 8
    s_add_u32 s50, s50, s86
    v_lshlrev_b32 v54, 2, v1
    v_add_u32 v54, s50, v54
    v_add_u32 v55, 0x10000, v54
    s_lshl_b32 s50, s29, 9
    s_add_u32 s50, s50, 4096
    v_and_b32 v56, 31, v1
    v_lshlrev_b32 v56, 4, v56
    v_add_u32 v56, s50, v56
    s_lshl_b32 s86, s30, 4
    s_add_u32 s50, s50, s86
    v_mov_b32 v57, s50
    s_mov_b32 s55, 1048576
    v_mov_b32 v58, 151696
Lwq_59:
    ds_read_b32 v59, v58
    s_waitcnt lgkmcnt(0)
    v_cmp_ne_u32 vcc, 4, v59
    s_cbranch_vccz Lwo_60
    s_sub_u32 s55, s55, 1
    s_cbranch_scc0 Lwq_59
    s_branch L_END
Lwo_60:
    ds_read_b64_tr_b16 v[80:81], v52 offset:0
    ds_read_b64_tr_b16 v[82:83], v52 offset:512
    ds_read_b64_tr_b16 v[84:85], v52 offset:32
    ds_read_b64_tr_b16 v[86:87], v52 offset:544
    ds_read_b64_tr_b16 v[88:89], v52 offset:64
    ds_read_b64_tr_b16 v[90:91], v52 offset:576
    ds_read_b64_tr_b16 v[92:93], v52 offset:96
    ds_read_b64_tr_b16 v[94:95], v52 offset:608
    s_waitcnt lgkmcnt(0)
    v_mfma_f32_16x16x32_bf16 v[144:147], v[64:67], v[80:83], 0
    v_mfma_f32_16x16x32_bf16 v[148:151], v[64:67], v[84:87], 0
    v_mfma_f32_16x16x32_bf16 v[152:155], v[64:67], v[88:91], 0
    v_mfma_f32_16x16x32_bf16 v[156:159], v[64:67], v[92:95], 0
    ds_read_b64_tr_b16 v[96:97], v52 offset:4096
    ds_read_b64_tr_b16 v[98:99], v52 offset:4608
    ds_read_b64_tr_b16 v[100:101], v52 offset:4128
    ds_read_b64_tr_b16 v[102:103], v52 offset:4640
    ds_read_b64_tr_b16 v[104:105], v52 offset:4160
    ds_read_b64_tr_b16 v[106:107], v52 offset:4672
    ds_read_b64_tr_b16 v[108:109], v52 offset:4192
    ds_read_b64_tr_b16 v[110:111], v52 offset:4704
    s_waitcnt lgkmcnt(0)
    v_mfma_f32_16x16x32_bf16 v[144:147], v[68:71], v[96:99], v[144:147]
    v_mfma_f32_16x16x32_bf16 v[148:151], v[68:71], v[100:103], v[148:151]
    v_mfma_f32_16x16x32_bf16 v[152:155], v[68:71], v[104:107], v[152:155]
    v_mfma_f32_16x16x32_bf16 v[156:159], v[68:71], v[108:111], v[156:159]
    ds_read_b64_tr_b16 v[112:113], v52 offset:8192
    ds_read_b64_tr_b16 v[114:115], v52 offset:8704
    ds_read_b64_tr_b16 v[116:117], v52 offset:8224
    ds_read_b64_tr_b16 v[118:119], v52 offset:8736
    ds_read_b64_tr_b16 v[120:121], v52 offset:8256
    ds_read_b64_tr_b16 v[122:123], v52 offset:8768
    ds_read_b64_tr_b16 v[124:125], v52 offset:8288
    ds_read_b64_tr_b16 v[126:127], v52 offset:8800
    s_waitcnt lgkmcnt(0)
    v_mfma_f32_16x16x32_bf16 v[144:147], v[72:75], v[112:115], v[144:147]
    v_mfma_f32_16x16x32_bf16 v[148:151], v[72:75], v[116:119], v[148:151]
    v_mfma_f32_16x16x32_bf16 v[152:155], v[72:75], v[120:123], v[152:155]
    v_mfma_f32_16x16x32_bf16 v[156:159], v[72:75], v[124:127], v[156:159]
    ds_read_b64_tr_b16 v[128:129], v52 offset:12288
    ds_read_b64_tr_b16 v[130:131], v52 offset:12800
    ds_read_b64_tr_b16 v[132:133], v52 offset:12320
    ds_read_b64_tr_b16 v[134:135], v52 offset:12832
    ds_read_b64_tr_b16 v[136:137], v52 offset:12352
    ds_read_b64_tr_b16 v[138:139], v52 offset:12864
    ds_read_b64_tr_b16 v[140:141], v52 offset:12384
    ds_read_b64_tr_b16 v[142:143], v52 offset:12896
    s_waitcnt lgkmcnt(0)
    v_mfma_f32_16x16x32_bf16 v[144:147], v[76:79], v[128:131], v[144:147]
    v_mfma_f32_16x16x32_bf16 v[148:151], v[76:79], v[132:135], v[148:151]
    v_mfma_f32_16x16x32_bf16 v[152:155], v[76:79], v[136:139], v[152:155]
    v_mfma_f32_16x16x32_bf16 v[156:159], v[76:79], v[140:143], v[156:159]
    s_waitcnt vmcnt(0)
    v_readfirstlane_b32 s53, v22
    s_and_b32 s53, s53, 255
    s_add_u32 s53, s53, 1
    s_cmp_eq_u32 s53, 256
    s_cselect_b32 s53, 1, s53
    v_mov_b32 v214, s53
    s_mov_b32 s55, 1048576
    s_mov_b32 s54, 0xffffff00
    s_lshl_b32 s86, s24, 8
    s_or_b32 s86, s86, s53
    v_mov_b32 v24, s86
    v_mov_b32 v25, v24
    v_mov_b32 v26, v24
    v_mov_b32 v27, v24
    v_cndmask_b32 v60, v144, v148, s[84:85]
    v_cndmask_b32 v64, v152, v156, s[84:85]
    v_cndmask_b32 v61, v145, v149, s[84:85]
    v_cndmask_b32 v65, v153, v157, s[84:85]
    v_cndmask_b32 v62, v146, v150, s[84:85]
    v_cndmask_b32 v66, v154, v158, s[84:85]
    v_cndmask_b32 v60, v60, v64, s[14:15]
    v_cndmask_b32 v61, v61, v65, s[14:15]
    v_cndmask_b32 v62, v62, v66, s[14:15]
    v_fma_f32 v60, -v62, s92, v60
    v_fma_f32 v61, -v62, s93, v61
    v_mul_f32 v60, s94, v60
    v_mul_f32 v61, s95, v61
    v_bfi_b32 v60, s54, v60, v214
    v_bfi_b32 v61, s54, v61, v214
    global_store_dword v54, v60, s[88:89] sc1
    global_store_dword v55, v61, s[88:89] sc1
    s_mov_b64 exec, 1
    global_store_dwordx4 v57, v[24:27], s[26:27] sc1
    s_mov_b64 exec, -1
    s_lshl_b32 s90, s35, 13
    s_add_u32 s88, s88, s90
    s_addc_u32 s89, s89, 0
    v_lshlrev_b32 v5, 3, v1
    v_add_u32 v5, 150528, v5
    v_add_u32 v4, 4096, v3
    s_sleep 24
Lq_61:
    global_load_dwordx4 v[64:67], v3, s[88:89] offset:0 sc1
    global_load_dwordx4 v[68:71], v3, s[88:89] offset:1024 sc1
    global_load_dwordx4 v[72:75], v3, s[88:89] offset:2048 sc1
    global_load_dwordx4 v[76:79], v3, s[88:89] offset:3072 sc1
    global_load_dwordx4 v[80:83], v4, s[88:89] offset:0 sc1
    global_load_dwordx4 v[84:87], v4, s[88:89] offset:1024 sc1
    global_load_dwordx4 v[88:91], v4, s[88:89] offset:2048 sc1
    global_load_dwordx4 v[92:95], v4, s[88:89] offset:3072 sc1
    global_load_dwordx4 v[96:99], v56, s[26:27] sc1
    s_waitcnt vmcnt(0)
    v_msad_u8 v16, v64, s53, 0
    v_msad_u8 v16, v65, s53, v16
    v_msad_u8 v16, v66, s53, v16
    v_msad_u8 v16, v67, s53, v16
    v_msad_u8 v16, v68, s53, v16
    v_msad_u8 v16, v69, s53, v16
    v_msad_u8 v16, v70, s53, v16
    v_msad_u8 v16, v71, s53, v16
    v_msad_u8 v16, v72, s53, v16
    v_msad_u8 v16, v73, s53, v16
    v_msad_u8 v16, v74, s53, v16
    v_msad_u8 v16, v75, s53, v16
    v_msad_u8 v16, v76, s53, v16
    v_msad_u8 v16, v77, s53, v16
    v_msad_u8 v16, v78, s53, v16
    v_msad_u8 v16, v79, s53, v16
    v_msad_u8 v16, v80, s53, v16
    v_msad_u8 v16, v81, s53, v16
    v_msad_u8 v16, v82, s53, v16
    v_msad_u8 v16, v83, s53, v16
    v_msad_u8 v16, v84, s53, v16
    v_msad_u8 v16, v85, s53, v16
    v_msad_u8 v16, v86, s53, v16
    v_msad_u8 v16, v87, s53, v16
    v_msad_u8 v16, v88, s53, v16
    v_msad_u8 v16, v89, s53, v16
    v_msad_u8 v16, v90, s53, v16
    v_msad_u8 v16, v91, s53, v16
    v_msad_u8 v16, v92, s53, v16
    v_msad_u8 v16, v93, s53, v16
    v_msad_u8 v16, v94, s53, v16
    v_msad_u8 v16, v95, s53, v16
    v_msad_u8 v16, v96, s53, v16
    v_msad_u8 v16, v97, s53, v16
    v_msad_u8 v16, v98, s53, v16
    v_msad_u8 v16, v99, s53, v16
    v_cmp_ne_u32 vcc, 0, v16
    s_cbranch_vccz Lok_62
    s_sub_u32 s55, s55, 1
    s_cbranch_scc0 Lq_61
    s_branch L_END
Lok_62:
    v_and_b32 v64, s54, v64
    v_and_b32 v65, s54, v65
    v_and_b32 v66, s54, v66
    v_and_b32 v67, s54, v67
    v_and_b32 v68, s54, v68
    v_and_b32 v69, s54, v69
    v_and_b32 v70, s54, v70
    v_and_b32 v71, s54, v71
    v_and_b32 v72, s54, v72
    v_and_b32 v73, s54, v73
    v_and_b32 v74, s54, v74
    v_and_b32 v75, s54, v75
    v_and_b32 v76, s54, v76
    v_and_b32 v77, s54, v77
    v_and_b32 v78, s54, v78
    v_and_b32 v79, s54, v79
    v_and_b32 v80, s54, v80
    v_and_b32 v81, s54, v81
    v_and_b32 v82, s54, v82
    v_and_b32 v83, s54, v83
    v_and_b32 v84, s54, v84
    v_and_b32 v85, s54, v85
    v_and_b32 v86, s54, v86
    v_and_b32 v87, s54, v87
    v_and_b32 v88, s54, v88
    v_and_b32 v89, s54, v89
    v_and_b32 v90, s54, v90
    v_and_b32 v91, s54, v91
    v_and_b32 v92, s54, v92
    v_and_b32 v93, s54, v93
    v_and_b32 v94, s54, v94
    v_and_b32 v95, s54, v95
    v_cmp_ne_u32 vcc, v96, v24
    v_add_f32 v64, v64, v72
    v_add_f32 v80, v80, v88
    v_add_f32 v65, v65, v73
    v_add_f32 v81, v81, v89
    v_add_f32 v66, v66, v74
    v_add_f32 v82, v82, v90
    v_add_f32 v67, v67, v75
    v_add_f32 v83, v83, v91
    v_add_f32 v68, v68, v76
    v_add_f32 v84, v84, v92
    v_add_f32 v69, v69, v77
    v_add_f32 v85, v85, v93
    v_add_f32 v70, v70, v78
    v_add_f32 v86, v86, v94
    v_add_f32 v71, v71, v79
    v_add_f32 v87, v87, v95
    s_cmp_eq_u64 vcc, 0
    s_cselect_b32 s24, 1, 0
    v_add_f32 v64, v64, v80
    v_add_f32 v65, v65, v81
    v_add_f32 v66, v66, v82
    v_add_f32 v67, v67, v83
    v_add_f32 v68, v68, v84
    v_add_f32 v69, v69, v85
    v_add_f32 v70, v70, v86
    v_add_f32 v71, v71, v87
    v_cvt_pk_bf16_f32 v16, v64, v65
    v_cvt_pk_bf16_f32 v17, v66, v67
    v_cvt_pk_bf16_f32 v18, v68, v69
    v_cvt_pk_bf16_f32 v19, v70, v71
    v_mov_b32 v6, 151680
    v_mov_b32 v8, v214
    v_mov_b32 v9, s24
    ds_write_b64 v6, v[8:9]
    ds_write_b64 v5, v[16:17]
    ds_write_b64 v5, v[18:19] offset:512
    s_waitcnt lgkmcnt(0)
    v_mov_b32 v6, 151692
    v_mov_b32 v7, 1
    ds_write_b32 v6, v7
    v_mov_b32 v4, 0
    s_lshl_b32 s50, s29, 19
    v_mov_b32 v5, s50
    global_load_dword v16, v5, s[12:13]
    global_load_dword v17, v4, s[16:17]
    global_load_dword v18, v4, s[18:19]
    global_load_dword v19, v4, s[20:21]
    global_load_dword v20, v4, s[22:23]
    v_mov_b32 v5, 1048576
    global_load_dword v21, v5, s[26:27]
    v_mov_b32 v5, 2097152
    global_load_dword v23, v5, s[26:27]
    s_setprio 0
    s_mov_b32 s28, 0
    s_mov_b32 s51, 0
    s_mov_b32 s52, 0
    s_lshl_b32 s34, s29, 4
    s_add_u32 s34, s34, s32
    s_mov_b32 s36, s6
    s_mov_b32 s37, s7
    s_mov_b32 s38, 67108864
    s_mov_b32 s39, 0x20000
    s_mov_b32 s40, s8
    s_mov_b32 s41, s9
    s_mov_b32 s42, 67108864
    s_mov_b32 s43, 0x20000
    s_mov_b64 s[56:57], 0
    s_mov_b64 s[58:59], 0
    s_mov_b64 s[60:61], 0
    s_mov_b64 s[62:63], 0
    s_mov_b64 s[76:77], 0
    s_mov_b64 s[78:79], 0
    s_mov_b64 s[80:81], 0
    s_mov_b64 s[82:83], 0
    s_mov_b32 s84, 0xffff0000
    s_mov_b32 s85, 0xffff0000
    s_mov_b32 s14, 0
    s_mov_b32 s15, -1
    s_lshr_b32 s95, s30, 3
    s_and_b32 s93, s30, 7
    s_mov_b32 s94, s95
    s_cmp_lt_u32 s29, 4
    s_cselect_b32 s86, 4, 3
    s_cmp_lt_u32 s95, s86
    s_cselect_b32 s25, -1, 0
    s_sub_u32 s86, s86, 1
    s_min_u32 s95, s95, s86
    s_and_b32 s6, s76, s25
    s_and_b32 s7, s77, s25
    s_and_b32 s8, s80, s25
    s_and_b32 s9, s81, s25
    s_and_b32 s10, s62, s25
    s_and_b32 s11, s63, s25
    s_lshl_b32 s92, s29, 2
    s_mul_i32 s86, s29, 3
    s_add_u32 s86, s86, 4
    s_cmp_lt_u32 s29, 4
    s_cselect_b32 s92, s92, s86
    s_add_u32 s92, s92, s95
    s_min_u32 s92, s92, 27
    s_lshl_b32 s33, s92, 2
    s_and_b32 s86, s30, 3
    s_add_u32 s33, s33, s86
    s_mov_b32 s44, s12
    s_mov_b32 s45, s13
    s_mov_b32 s46, 4194304
    s_mov_b32 s47, 0x20000
    s_mov_b32 s64, s16
    s_mov_b32 s65, s17
    s_mov_b32 s66, 1835008
    s_mov_b32 s67, 0x20000
    s_mov_b32 s68, s18
    s_mov_b32 s69, s19
    s_mov_b32 s70, 1835008
    s_mov_b32 s71, 0x20000
    s_mov_b32 s72, s20
    s_mov_b32 s73, s21
    s_mov_b32 s74, 1835008
    s_mov_b32 s75, 0x20000
    v_and_b32 v48, 15, v1
    v_lshrrev_b32 v49, 4, v1
    v_lshrrev_b32 v52, 2, v48
    v_and_b32 v53, 3, v1
    v_lshlrev_b32 v53, 3, v53
    v_lshrrev_b32 v50, 3, v1
    v_and_b32 v51, 7, v1
    v_lshlrev_b32 v51, 4, v51
    v_lshl_add_u32 v216, v50, 10, v51
    v_mul_u32_u24 v50, 3584, v50
    v_add_u32 v217, v50, v51
    v_lshlrev_b32 v50, 10, v49
    v_lshl_add_u32 v218, v48, 4, v50
    s_mul_i32 s86, s28, 2112
    s_add_u32 s86, s86, 131072
    v_and_b32 v50, 3, v1
    v_mul_u32_u24 v50, 528, v50
    v_lshl_add_u32 v50, v52, 6, v50
    v_lshl_add_u32 v50, v49, 4, v50
    v_add_u32 v219, s86, v50
    s_lshl_b32 s86, s28, 2
    s_add_u32 s86, s86, 151616
    v_and_b32 v50, 3, v1
    v_lshlrev_b32 v50, 4, v50
    v_add_u32 v220, s86, v50
    s_mul_i32 s86, s28, 528
    s_add_u32 s86, s86, 131072
    v_lshlrev_b32 v50, 3, v1
    v_add_u32 v221, s86, v50
    s_lshl_b32 s86, s28, 4
    s_add_u32 s86, s86, 151552
    v_mov_b32 v222, s86
    v_subrev_u32 v254, -64, v222
    s_lshl_b32 s86, s28, 9
    v_lshlrev_b32 v50, 3, v1
    v_add_u32 v223, s86, v50
    s_lshl_b32 s86, s28, 4
    s_add_u32 s86, s86, 2048
    v_mov_b32 v224, s86
    v_lshlrev_b32 v50, 12, v49
    v_lshl_add_u32 v225, v48, 4, v50
    v_add_u32 v226, 16384, v225
    v_add_u32 v227, 32768, v225
    v_add_u32 v228, 49152, v225
    v_and_b32 v50, 3, v1
    v_lshl_add_u32 v50, v50, 2, v49
    v_lshlrev_b32 v50, 12, v50
    s_mul_i32 s86, s94, 496
    s_and_b32 s87, s28, 1
    s_lshl_b32 s87, s87, 8
    s_add_u32 s86, s86, s87
    s_sub_u32 s86, 2048, s86
    v_add_u32 v229, s86, v50
    s_lshl_b32 s86, s28, 7
    s_add_u32 s86, s86, 151744
    v_lshlrev_b32 v50, 3, v48
    v_lshl_add_u32 v50, v49, 1, v50
    v_add_u32 v230, s86, v50
    v_and_b32 v50, 1, v1
    v_lshlrev_b32 v50, 8, v50
    v_lshl_add_u32 v50, v49, 4, v50
    v_add_u32 v231, 151744, v50
    s_lshl_b32 s86, s28, 5
    v_lshl_add_u32 v50, v49, 3, v52
    v_lshl_add_u32 v50, v50, 7, v53
    v_add_u32 v50, s86, v50
    v_add_u32 v232, 24576, v50
    v_add_u32 v233, 90112, v50
    v_and_b32 v50, 1, v49
    v_lshl_add_u32 v50, v50, 3, v52
    v_lshl_add_u32 v50, v50, 7, v53
    v_lshrrev_b32 v51, 1, v49
    v_lshl_add_u32 v50, v51, 15, v50
    v_add_u32 v50, s86, v50
    v_add_u32 v243, 28672, v50
    v_add_u32 v244, 94208, v50
    v_lshl_add_u32 v50, v49, 2, v52
    v_lshlrev_b32 v50, 8, v50
    v_lshl_add_u32 v50, v53, 3, v50
    v_add_u32 v50, s51, v50
    v_add_u32 v245, 0, v50
    s_lshl_b32 s86, s29, 2
    s_add_u32 s86, s86, s94
    s_lshl_b32 s86, s86, 11
    s_lshl_b32 s87, s93, 8
    s_add_u32 s86, s86, s87
    s_lshl_b32 s87, s28, 6
    s_add_u32 s86, s86, s87
    v_and_b32 v50, 1, v49
    v_lshlrev_b32 v50, 16, v50
    v_lshl_add_u32 v50, v48, 2, v50
    v_add_u32 v234, s86, v50
    s_lshl_b32 s86, s28, 14
    s_lshl_b32 s87, s93, 8
    s_add_u32 s86, s86, s87
    v_lshlrev_b32 v50, 11, v49
    v_lshl_add_u32 v50, v48, 4, v50
    v_add_u32 v235, s86, v50
    v_add_u32 v236, 8192, v235
    v_add_u32 v237, 0x10000, v235
    v_add_u32 v238, 0x12000, v235
    s_lshl_b32 s86, s28, 9
    s_add_u32 s86, s86, 152256
    v_lshlrev_b32 v50, 4, v48
    v_lshl_add_u32 v50, v49, 2, v50
    v_add_u32 v239, s86, v50
    v_lshrrev_b32 v50, 5, v1
    v_and_b32 v51, 31, v1
    v_lshlrev_b32 v54, 8, v50
    v_lshl_add_u32 v54, v51, 3, v54
    v_add_u32 v240, 152256, v54
    s_lshl_b32 s86, s28, 8
    s_add_u32 s86, s86, 154304
    v_lshlrev_b32 v54, 7, v50
    v_lshl_add_u32 v54, v51, 2, v54
    v_add_u32 v241, s86, v54
    v_and_b32 v50, 1, v1
    v_lshlrev_b32 v50, 7, v50
    v_lshl_add_u32 v50, v49, 4, v50
    v_add_u32 v50, s86, v50
    v_and_b32 v51, 2, v1
    v_cmp_ne_u32 vcc, 0, v51
    v_mov_b32 v54, 149504
    s_nop 0
    v_cndmask_b32 v242, v50, v54, vcc
    s_lshl_b32 s86, s28, 12
    s_lshl_b32 s87, s93, 9
    s_add_u32 s86, s86, s87
    v_and_b32 v50, 1, v49
    v_lshlrev_b32 v50, 14, v50
    v_lshl_add_u32 v50, v48, 4, v50
    v_add_u32 v246, s86, v50
    s_add_u32 s86, s86, 256
    v_lshrrev_b32 v50, 5, v1
    v_lshlrev_b32 v50, 14, v50
    v_add_u32 v247, s86, v50
    v_lshlrev_b32 v50, 9, v49
    v_lshl_add_u32 v248, v48, 4, v50
    v_and_b32 v50, 7, v1
    v_lshlrev_b32 v50, 9, v50
    v_add_u32 v249, 256, v50
    s_lshl_b32 s86, s28, 9
    v_lshlrev_b32 v50, 7, v49
    v_lshl_add_u32 v50, v48, 4, v50
    v_add_u32 v250, s86, v50
    v_and_b32 v50, 31, v1
    v_lshlrev_b32 v251, 11, v50
    v_lshlrev_b32 v252, 11, v1
    v_add_u32 v255, 0x20000, v252
    v_lshlrev_b32 v253, 1, v49
    s_mov_b64 exec, 0
    s_branch L_TAIL
.section .rodata,"a"
.p2align 6
.amdhsa_kernel sequential_preLN__gqa_block_cached__swiglu_ffn__decode_kernel
  .amdhsa_next_free_vgpr 256
  .amdhsa_next_free_sgpr 102
  .amdhsa_accum_offset 256
  .amdhsa_group_segment_fixed_size 0
  .amdhsa_kernarg_size 96
  .amdhsa_user_sgpr_count 2
  .amdhsa_user_sgpr_kernarg_segment_ptr 1
  .amdhsa_system_sgpr_workgroup_id_x 1
.end_amdhsa_kernel
```
